```python
import torch

def _softmax(x, axis=-1):
    return torch.softmax(x, dim=axis)

def _gelu(x):
    return torch.nn.functional.gelu(x, approximate='tanh')

def _silu(x):
    return torch.nn.functional.silu(x)

def _sigmoid(x):
    return torch.sigmoid(x)

def _layernorm(x, axis=-1, eps=1e-05):
    m = x.mean(dim=axis, keepdim=True)
    v = x.var(dim=axis, keepdim=True, unbiased=False)
    return (x - m) / torch.sqrt(v + eps)

def _scatter_add(tgt, idx, src, axis=0):
    return tgt.clone().index_add_(axis, idx, src)

def _segment_sum(src, seg, n):
    out = torch.zeros((n,) + src.shape[1:], dtype=src.dtype)
    return out.index_add_(0, seg, src)

def _pad(x, pw):
    flat = tuple((v for pair in reversed(pw) for v in pair))
    return torch.nn.functional.pad(x, flat)
kernel_name = 'adaLN_cond__linear_kernel_hedgehog__glu_gated_glu__prompt'

def setup_inputs():

    _w = lambda a: (lambda t: t.to(torch.bfloat16) if t.is_floating_point() else t)(torch.as_tensor(a))

    def _A_setup():
        B, S, D, H = (1, 2048, 512, 32)
        Dh = D // H
        return {'x': _w((lambda *s: torch.randn(*s, dtype=torch.bfloat16) * 0.05)(B, S, D)), 'wqkv': _w((lambda *s: torch.randn(*s, dtype=torch.bfloat16) * 0.4)(D, 3 * D)), 'w_phi': _w((lambda *s: torch.randn(*s, dtype=torch.bfloat16) * 0.4)(H, Dh, Dh) * Dh ** (-0.5)), 'wo': _w((lambda *s: torch.randn(*s, dtype=torch.bfloat16) * 0.05)(D, D))}
    _A_in = _A_setup()

    def _B_setup():
        B, S, D, F = (1, 2048, 512, 1376)
        return {'x': _w((lambda *s: torch.randn(*s, dtype=torch.bfloat16) * 0.05)(B, S, D)), 'w_gate': _w((lambda *s: torch.randn(*s, dtype=torch.bfloat16) * 0.1)(D, F)), 'w_up': _w((lambda *s: torch.randn(*s, dtype=torch.bfloat16) * 0.05)(D, F)), 'w_down': _w((lambda *s: torch.randn(*s, dtype=torch.bfloat16) * 0.05)(F, D))}
    _B_in = _B_setup()
    return {'A_x': _A_in['x'], 'A_wqkv': _A_in['wqkv'], 'A_w_phi': _A_in['w_phi'], 'A_wo': _A_in['wo'], 'B_x': _B_in['x'], 'B_w_gate': _B_in['w_gate'], 'B_w_up': _B_in['w_up'], 'B_w_down': _B_in['w_down'], 'c': _w((lambda *s: torch.randn(*s, dtype=torch.bfloat16) * 0.2)(1, 512) * 8.0), 'w_mod': _w((lambda *s: torch.randn(*s, dtype=torch.bfloat16) * 0.2)(512, 6 * 512) * 512 ** (-0.5) * 8.0)}

def reference(A_x, A_wqkv, A_w_phi, A_wo, B_x, B_w_gate, B_w_up, B_w_down, c, w_mod):

    def _A_ref(x, wqkv, w_phi, wo):
        B, S, D = x.shape
        H = 32
        Dh = D // H
        qkv = (lambda x, *d: x.permute(*d))((x @ wqkv).reshape(B, S, 3, H, Dh), 2, 0, 3, 1, 4)
        q, k, v = (qkv[0], qkv[1], qkv[2])
        pq = torch.einsum('bhsd,hdf->bhsf', q, w_phi)
        pk = torch.einsum('bhsd,hdf->bhsf', k, w_phi)
        phi_q = torch.concatenate([_softmax(pq, axis=-1), _softmax(-pq, axis=-1)], axis=-1)
        phi_k = torch.concatenate([_softmax(pk, axis=-1), _softmax(-pk, axis=-1)], axis=-1)
        kv = torch.einsum('bhsf,bhsd->bhfd', phi_k, v)
        z = torch.einsum('bhsf->bhf', phi_k)
        num = torch.einsum('bhqf,bhfd->bhqd', phi_q, kv)
        den = torch.einsum('bhqf,bhf->bhq', phi_q, z)[..., None] + 1e-06
        o = num / den
        return (lambda x, *d: x.permute(*d))(o, 0, 2, 1, 3).reshape(B, S, D) @ wo

    def _B_ref(x, w_gate, w_up, w_down):
        g = torch.einsum('bsd,df->bsf', x, w_gate)
        u = torch.einsum('bsd,df->bsf', x, w_up)
        h = _sigmoid(g) * u
        return torch.einsum('bsf,fd->bsd', h, w_down)
    x = A_x
    mod = (_silu(c) @ w_mod).reshape(c.shape[0], 6, 1, -1)
    sa, ca, ga, sb, cb, gb = (mod[:, 0].clone(), mod[:, 1].clone(), mod[:, 2].clone(), mod[:, 3].clone(), mod[:, 4].clone(), mod[:, 5].clone())
    h = _layernorm(x, axis=-1) * (1 + ca) + sa
    x = x + ga * _A_ref(h, A_wqkv, A_w_phi, A_wo)
    h = _layernorm(x, axis=-1) * (1 + cb) + sb
    x = x + gb * _B_ref(h, B_w_gate, B_w_up, B_w_down)
    return x
```

```asm
; @launch grid=(256,1,1) block=(256,1,1) lds=163840
.amdgcn_target "amdgcn-amd-amdhsa--gfx950"
.text
.p2align 12
.globl adaLN_cond__linear_kernel_hedgehog__glu_gated_glu__prompt_kernel
.p2align 8
.type adaLN_cond__linear_kernel_hedgehog__glu_gated_glu__prompt_kernel,@function
adaLN_cond__linear_kernel_hedgehog__glu_gated_glu__prompt_kernel:
L_start:
    s_getpc_b64 s[60:61]
    s_cmp_ge_u32 s2, 256
    s_cbranch_scc1 L_exit
    s_load_dwordx16 s[4:19], s[0:1], 0
    s_load_dwordx8 s[20:27], s[0:1], 64
    s_load_dwordx2 s[28:29], s[0:1], 96
    v_lshrrev_b32 v4, 6, v0
    s_bfe_u32 s62, s2, 0x40003
    v_lshlrev_b32 v5, 7, v0
    v_cmp_eq_u32 vcc, s62, v4
    v_add_u32 v6, 0x8000, v5
    v_min_u32 v6, L_last-L_start-4, v6
    v_min_u32 v5, L_last-L_start-4, v5
    s_mov_b64 exec, vcc
    s_cbranch_execz L_notouch
    global_load_dword v63, v5, s[60:61]
    global_load_dword v63, v6, s[60:61]
L_notouch:
    s_mov_b64 exec, -1
    v_readfirstlane_b32 s3, v4
    v_and_b32 v1, 63, v0
    s_and_b32 s30, s2, 7
    s_lshr_b32 s31, s2, 3
    v_lshlrev_b32 v2, 4, v1
    v_lshrrev_b32 v101, 3, v0
    s_movk_i32 s62, 6144
    v_mul_u32_u24 v100, s62, v101
    v_and_b32 v13, 0x70, v2
    v_add_u32 v100, v100, v13
    s_and_b32 s47, s2, 3
    s_lshr_b32 s48, s2, 5
    s_lshl_b32 s48, s48, 3
    s_sub_u32 s48, s2, s48
    s_lshr_b32 s48, s48, 2
    s_mul_i32 s64, s47, 786432
    s_lshl_b32 s62, s48, 7
    s_add_u32 s64, s64, s62
    s_add_u32 s65, s64, 196608
    s_add_u32 s66, s64, 393216
    s_add_u32 s67, s64, 589824
    s_and_b32 s62, s2, 24
    s_cmp_lg_u32 s62, 24
    s_cselect_b32 s42, 3145728, 0
    s_mov_b32 s43, 0x20000
    s_lshl_b32 s62, s47, 8
    v_lshl_add_u32 v101, v101, 1, s62
    s_mul_i32 s47, s47, 12288
    s_lshl_b32 s48, s48, 8
    s_add_u32 s47, s47, s48
    s_add_u32 s47, s47, 458752
    s_and_b32 s44, s30, 6
    s_lshl_b32 s44, s44, 2
    s_lshr_b32 s45, s31, 2
    s_add_u32 s44, s44, s45
    s_and_b32 s45, s30, 1
    s_lshl_b32 s45, s45, 2
    s_and_b32 s62, s31, 3
    s_add_u32 s45, s45, s62
    s_lshl_b32 s62, s44, 16
    s_lshl_b32 s63, s3, 13
    s_add_u32 s62, s62, s63
    s_and_b32 s63, s31, 1
    s_lshl_b32 s63, s63, 12
    s_add_u32 s62, s62, s63
    s_and_b32 s63, s31, 2
    s_lshl_b32 s63, s63, 14
    s_add_u32 s62, s62, s63
    v_add_u32 v102, s62, v2
    v_xor_b32 v103, 0x1000, v102
    v_xor_b32 v107, 0x8000, v102
    v_xor_b32 v108, 0x9000, v102
    s_waitcnt lgkmcnt(0)
    s_load_dword s100, s[28:29], 32768
    s_mov_b32 s40, s22
    s_mov_b32 s41, s23
    buffer_load_dwordx4 v[16:19], v100, s[40:43], s64 offen
    buffer_load_dwordx4 v[20:23], v100, s[40:43], s65 offen
    buffer_load_dwordx4 v[24:27], v100, s[40:43], s66 offen
    buffer_load_dwordx4 v[28:31], v100, s[40:43], s67 offen
    global_load_ushort v32, v101, s[20:21]
    global_load_ushort v33, v101, s[20:21] offset:64
    global_load_ushort v34, v101, s[20:21] offset:128
    global_load_ushort v35, v101, s[20:21] offset:192
    s_mov_b32 s40, s6
    s_mov_b32 s41, s7
    s_mov_b32 s42, 1572864
    global_load_dwordx4 v[192:195], v102, s[4:5] offset:0
    global_load_dwordx4 v[196:199], v102, s[4:5] offset:1024
    global_load_dwordx4 v[200:203], v102, s[4:5] offset:2048
    global_load_dwordx4 v[204:207], v102, s[4:5] offset:3072
    global_load_dwordx4 v[208:211], v103, s[4:5] offset:0
    global_load_dwordx4 v[212:215], v103, s[4:5] offset:1024
    s_sub_u32 s69, 255, s2
    s_and_b32 s58, s3, 1
    s_lshr_b32 s59, s3, 1
    s_cmp_ge_u32 s69, 128
    s_cbranch_scc1 L_wd
    s_mov_b32 s68, s59
    s_mov_b32 s38, 1409024
    s_lshr_b32 s60, s69, 2
    s_and_b32 s61, s69, 3
    s_lshl_b32 s49, s60, 4
    s_lshl_b32 s62, s58, 3
    s_add_u32 s49, s49, s62
    s_mul_i32 s49, s49, 2752
    s_mul_i32 s62, s61, 704
    s_add_u32 s49, s49, s62
    s_movk_i32 s50, 2752
    s_movk_i32 s51, 5632
    s_movk_i32 s52, 11296
    s_lshl_b32 s53, s3, 5
    s_movk_i32 s54, 2816
    s_mul_i32 s55, s61, 22
    s_add_u32 s55, s55, s3
    s_lshl_b32 s55, s55, 5
    s_add_u32 s55, s55, s60
    s_lshl_b32 s55, s55, 10
    s_add_u32 s55, s55, 3145728
    s_mov_b32 s56, 131072
    s_cmp_eq_u32 s61, 3
    s_cselect_b32 s57, 23, 25
    s_sub_u32 s57, s57, s3
    s_lshr_b32 s57, s57, 2
    s_movk_i32 s1, 0xfff
    s_branch L_go
L_wd:
    s_cmp_ge_u32 s69, 214
    s_cbranch_scc1 L_wo
    s_mov_b32 s68, 2
    s_mov_b32 s38, 1409024
    s_sub_u32 s60, s69, 128
    s_movk_i32 s51, 5632
    s_mul_i32 s53, s58, 11296
    s_movk_i32 s54, 2816
    s_movk_i32 s62, 86
    s_mov_b32 s63, 1572864
    s_branch L_cmn
L_wo:
    s_mov_b32 s68, 3
    s_mov_b32 s38, 524288
    s_sub_u32 s60, s69, 214
    s_movk_i32 s51, 2816
    s_mul_i32 s53, s58, 5632
    s_movk_i32 s54, 11296
    s_movk_i32 s62, 32
    s_mov_b32 s63, 1048576
L_cmn:
    s_and_b32 s61, s60, 1
    s_lshr_b32 s60, s60, 1
    s_lshl_b32 s49, s60, 15
    s_lshl_b32 s50, s3, 13
    s_add_u32 s49, s49, s50
    s_lshl_b32 s50, s61, 9
    s_add_u32 s49, s49, s50
    s_movk_i32 s50, 1024
    s_movk_i32 s52, 32
    s_lshl_b32 s55, s59, 6
    s_add_u32 s53, s53, s55
    s_lshl_b32 s55, s61, 3
    s_add_u32 s55, s55, s59
    s_mul_i32 s55, s55, s62
    s_lshl_b32 s60, s60, 1
    s_add_u32 s55, s55, s60
    s_add_u32 s55, s55, s58
    s_lshl_b32 s55, s55, 10
    s_add_u32 s55, s55, s63
    s_lshl_b32 s56, s62, 11
    s_cmp_ge_u32 s69, 246
    s_cselect_b32 s55, 0x8000000, s55
    s_mov_b32 s57, 4
    s_mov_b32 s1, 0
L_go:
    s_mov_b32 s39, 0x20000
    s_add_u32 s53, s53, 134144
    s_mul_i32 s48, s3, 5632
    s_lshl_b32 s61, s59, 5
    s_add_u32 s48, s48, s61
    s_add_u32 s48, s48, 134144
    s_mov_b32 s46, 0x3fb8aa3b
    v_lshrrev_b32 v4, 4, v0
    s_lshl_b32 s62, s31, 4
    v_add_u32 v4, s62, v4
    s_movk_i32 s62, 3072
    v_mul_u32_u24 v4, s62, v4
    v_and_b32 v5, 3, v1
    v_lshl_add_u32 v4, v5, 7, v4
    s_and_b32 s62, s30, 1
    s_lshl_b32 s62, s62, 9
    v_add_u32 v4, s62, v4
    v_mov_b32 v104, v4
    v_and_b32 v4, 7, v1
    v_lshrrev_b32 v3, 3, v1
    s_movk_i32 s62, 3072
    v_mul_u32_u24 v3, s62, v3
    v_bfe_u32 v7, v1, 4, 1
    v_lshlrev_b32 v10, 2, v7
    v_xor_b32 v10, v10, v4
    v_lshl_add_u32 v8, v10, 4, v3
    v_lshlrev_b32 v7, 1, v7
    v_xor_b32 v10, v4, v7
    s_and_b32 s59, s3, 2
    s_lshl_b32 s62, s59, 1
    v_xor_b32 v10, s62, v10
    v_lshl_add_u32 v56, v10, 4, v3
    v_add_u32 v57, 23552, v56
    v_add_u32 v58, 47104, v56
    v_add_u32 v59, 70656, v56
    s_lshl_b32 s59, s59, 9
    s_lshl_b32 s62, s45, 7
    s_add_u32 s59, s59, s62
    s_add_u32 s59, s59, 1024
    s_mul_i32 s62, s58, 786432
    s_add_u32 s59, s59, s62
    s_lshl_b32 s95, s3, 15
    s_bfe_u32 s94, s31, 196610
    s_cmp_eq_u32 s68, 0
    s_cselect_b64 s[36:37], s[14:15], s[16:17]
    s_cmp_eq_u32 s68, 2
    s_cselect_b64 s[36:37], s[18:19], s[36:37]
    s_cmp_eq_u32 s68, 3
    s_cselect_b64 s[36:37], s[10:11], s[36:37]
    s_mov_b32 s32, s28
    s_mov_b32 s33, s29
    s_mov_b32 s34, 25165824
    s_mov_b32 s35, 0x20000
    v_lshrrev_b32 v7, 4, v1
    v_lshlrev_b32 v7, 3, v7
    v_lshl_add_u32 v96, v4, 5, v7
    s_lshl_b32 s62, s3, 8
    s_add_u32 s62, s62, 159232
    v_add_u32 v96, s62, v96
    v_and_b32 v97, 0xf0, v2
    v_add_u32 v97, 159232, v97
    s_and_b32 s62, s2, 24
    s_cmp_lg_u32 s62, 24
    s_cselect_b32 s47, s47, 0x8000000
    s_cmp_eq_u32 s3, 0
    s_cselect_b32 s47, s47, 0x8000000
    s_lshl_b32 s62, s45, 7
    s_mul_i32 s0, s3, 393216
    s_add_u32 s0, s0, s62
    s_lshl_b32 s62, s45, 11
    v_add_u32 v98, s62, v2
    v_bfe_u32 v60, v1, 2, 2
    s_movk_i32 s60, 704
    v_mul_u32_u24 v60, s60, v60
    v_lshrrev_b32 v61, 5, v1
    v_mad_u32_u24 v60, v61, s51, v60
    v_bfe_u32 v61, v1, 4, 1
    v_mad_u32_u24 v60, v61, s52, v60
    v_and_b32 v4, 1, v1
    v_lshlrev_b32 v4, 4, v4
    v_and_b32 v5, 2, v1
    v_lshl_add_u32 v4, v5, 2, v4
    v_add3_u32 v60, v60, v4, s53
    v_add_u32 v61, s54, v60
    v_bfe_u32 v5, v1, 2, 2
    v_lshrrev_b32 v6, 5, v1
    v_lshl_add_u32 v5, v6, 3, v5
    v_lshl_add_u32 v9, v5, 7, v4
    v_bfe_u32 v6, v1, 3, 2
    v_xor_b32 v6, s3, v6
    v_lshl_add_u32 v6, v6, 5, v9
    v_bfe_u32 v7, v1, 4, 1
    v_lshl_add_u32 v36, v7, 16, v6
    s_lshl_b32 s61, s58, 1
    v_bfe_u32 v10, v1, 3, 1
    v_lshlrev_b32 v10, 1, v10
    v_xor_b32 v10, s61, v10
    v_add_u32 v10, v10, v7
    v_lshl_add_u32 v9, v10, 5, v9
    v_add_u32 v9, 66560, v9
    v_lshlrev_b32 v5, 5, v5
    v_lshl_add_u32 v5, v7, 4, v5
    v_and_b32 v10, 2, v1
    v_lshl_add_u32 v5, v10, 2, v5
    v_add_u32 v5, 132096, v5
    s_lshl_b32 s60, s3, 9
    v_add_u32 v37, s60, v5
    s_lshl_b32 s61, s58, 10
    v_add_u32 v38, s61, v5
    s_add_u32 s60, s60, 157184
    v_lshlrev_b32 v39, 3, v1
    v_add_u32 v39, s60, v39
    s_lshl_b32 s84, s30, 3
    s_lshr_b32 s85, s31, 2
    s_add_u32 s84, s84, s85
    s_and_b32 s85, s31, 3
    s_lshl_b32 s85, s85, 2
    s_add_u32 s85, s85, s3
    s_lshl_b32 s86, s85, 15
    s_add_u32 s86, s86, 1048576
    s_and_b32 s87, s30, 4
    s_lshl_b32 s87, s87, 1
    s_lshr_b32 s88, s31, 2
    s_add_u32 s87, s87, s88
    s_and_b32 s88, s31, 3
    s_lshl_b32 s88, s88, 2
    s_and_b32 s60, s30, 3
    s_add_u32 s88, s88, s60
    s_lshl_b32 s89, s88, 1
    s_lshr_b32 s60, s3, 1
    s_add_u32 s89, s89, s60
    s_add_u32 s90, s89, 32
    s_mul_i32 s60, s58, 54
    s_add_u32 s89, s89, s60
    s_lshl_b32 s26, s89, 15
    s_add_u32 s26, s26, 3145728
    s_lshl_b32 s27, s90, 15
    s_add_u32 s27, s27, 3145728
    s_cmp_gt_u32 s90, 53
    s_cselect_b32 s27, 0x8000000, s27
    s_lshl_b32 s83, s84, 4
    s_add_u32 s83, s83, s85
    s_lshl_b32 s17, s83, 8
    s_add_u32 s17, s17, 131072
    s_lshl_b32 s83, s83, 11
    s_add_u32 s16, s83, 15728640
    s_add_u32 s83, s83, 13631488
    s_mul_i32 s10, s85, 6
    s_min_u32 s10, s10, 80
    s_mul_i32 s11, s84, 86
    s_add_u32 s10, s10, s11
    s_lshl_b32 s10, s10, 10
    s_add_u32 s10, s10, 17825792
    global_load_dwordx4 v[216:219], v103, s[4:5] offset:2048
    s_add_u32 s11, s10, 3072
    s_mul_i32 s60, s3, 8320
    v_add_u32 v3, s60, v2
    v_and_b32 v4, 31, v1
    v_lshrrev_b32 v7, 5, v1
    s_movk_i32 s61, 112
    s_mul_i32 s23, s3, 7168
    s_add_u32 s23, s23, 134144
    v_mul_u32_u24 v5, s61, v4
    v_add_u32 v5, s23, v5
    v_lshl_add_u32 v11, v7, 4, v5
    v_lshl_add_u32 v5, v7, 5, v5
    s_movk_i32 s60, 1040
    v_mul_u32_u24 v4, s60, v4
    v_lshl_add_u32 v4, v7, 4, v4
    v_and_b32 v14, 0xf0, v2
    v_lshl_add_u32 v14, v7, 9, v14
    v_bfe_u32 v7, v1, 4, 1
    v_lshl_add_u32 v14, v7, 15, v14
    s_and_b32 s60, s31, 1
    s_lshl_b32 s60, s60, 6
    v_xor_b32 v14, s60, v14
    v_lshrrev_b32 v13, 4, v1
    v_bfe_u32 v7, v1, 2, 2
    v_lshl_add_u32 v6, v13, 3, v7
    v_mul_u32_u24 v6, s61, v6
    v_add_u32 v6, s23, v6
    v_and_b32 v7, 3, v1
    v_lshl_add_u32 v10, v7, 3, v6
    v_lshl_add_u32 v6, v7, 4, v6
    s_lshl_b32 s19, s45, 2
    s_add_u32 s19, s19, s3
    s_mul_i32 s18, s19, 67584
    s_lshl_b32 s60, s44, 8
    s_add_u32 s18, s18, s60
    s_add_u32 s18, s18, 6291456
    s_lshl_b32 s19, s19, 13
    s_add_u32 s19, s19, s60
    s_add_u32 s19, s19, 8650752
    v_and_b32 v7, 16, v2
    v_bfe_u32 v12, v1, 1, 2
    s_movk_i32 s60, 12288
    v_mad_u32_u24 v12, v12, s60, v7
    v_lshl_add_u32 v7, v13, 5, v7
    v_lshrrev_b32 v13, 3, v1
    s_movk_i32 s60, 8448
    v_and_b32 v15, 0x70, v2
    v_mad_u32_u24 v13, v13, s60, v15
    s_lshl_b32 s20, s3, 11
    s_add_u32 s20, s20, 8192
    s_lshl_b32 s21, s44, 1
    s_and_b32 s60, s31, 2
    s_xor_b32 s60, s60, s3
    s_lshr_b32 s60, s60, 1
    s_add_u32 s21, s21, s60
    s_lshr_b32 s60, s3, 1
    s_mul_i32 s60, s60, 33280
    v_add_u32 v15, s60, v4
    s_lshl_b32 s21, s21, 6
    s_lshl_b32 s60, s45, 2
    global_load_dwordx4 v[220:223], v103, s[4:5] offset:3072
    s_add_u32 s21, s21, s60
    s_lshl_b32 s60, s58, 1
    s_add_u32 s21, s21, s60
    s_lshl_b32 s21, s21, 10
    s_add_u32 s21, s21, 9437184
    s_lshl_b32 s80, s2, 7
    s_mul_i32 s82, s2, 8448
    s_lshl_b32 s60, s3, 7
    s_add_u32 s82, s82, s60
    s_add_u32 s82, s82, 6291456
    s_lshl_b32 s60, s3, 3
    s_add_u32 s80, s80, s60
    s_add_u32 s80, s80, 65536
    s_lshl_b32 s60, s31, 13
    s_add_u32 s60, s60, 8650752
    s_lshl_b32 s61, s31, 6
    s_add_u32 s61, s61, 98304
    s_xor_b32 s81, s31, s30
    s_and_b32 s81, s81, 7
    s_add_u32 s81, s81, s3
    s_cmp_eq_u32 s81, 2
    s_cselect_b32 s60, s60, 0x8000000
    s_cselect_b32 s61, s61, 0x8000000
    s_cmp_lt_u32 s3, 2
    s_cselect_b32 s82, s82, s60
    s_cselect_b32 s80, s80, s61
    s_cselect_b32 s81, 4, 3
    s_add_u32 s22, s82, 4096
    s_lshl_b32 s63, s3, 10
    s_add_u32 s12, s63, 458752
    s_add_u32 s13, s12, 12288
    s_add_u32 s14, s12, 24576
    s_add_u32 s15, s12, 36864
    s_lshl_b32 s52, s2, 5
    s_add_u32 s53, s52, 8192
    s_add_u32 s52, s52, 462848
    s_cmp_eq_u32 s3, 0
    s_cselect_b32 s53, s53, 0x8000000
    s_sub_u32 s62, s69, 214
    s_and_b32 s60, s62, 1
    s_add_u32 s60, s60, 4
    s_lshr_b32 s61, s62, 1
    s_and_b32 s54, s69, 3
    s_lshr_b32 s63, s69, 2
    s_cmp_lt_u32 s69, 128
    s_cselect_b32 s60, s54, s60
    s_cselect_b32 s61, s63, s61
    s_cselect_b32 s62, 0, s62
    s_lshl_b32 s54, s60, 9
    s_and_b32 s60, s61, 1
    s_lshl_b32 s60, s60, 2
    s_add_u32 s54, s54, s60
    s_lshr_b32 s61, s61, 1
    s_lshl_b32 s61, s61, 5
    s_add_u32 s54, s54, s61
    s_add_u32 s54, s54, 393216
    s_lshl_b32 s60, s3, 5
    s_or_b32 s62, s62, s60
    s_cmp_lt_u32 s62, 32
    s_cselect_b32 s54, s54, 0x8000000
    s_lshl_b32 s58, s3, 14
    s_add_u32 s58, s58, 66560
    v_and_b32 v105, 7, v1
    v_lshlrev_b32 v105, s81, v105
    v_lshrrev_b32 v106, 5, v1
    v_lshl_add_u32 v105, v106, 2, v105
    v_mov_b32 v106, -1
    s_cmp_eq_u32 s3, 0
    s_cbranch_scc1 T_0
    s_cmp_eq_u32 s3, 1
    s_cbranch_scc1 T_1
    s_cmp_eq_u32 s3, 2
    s_cbranch_scc1 T_2
    s_branch T_3
L_back:
    s_waitcnt vmcnt(8)
    v_lshlrev_b32 v32, 16, v32
    global_load_dwordx4 v[224:227], v107, s[4:5] offset:0
    v_lshlrev_b32 v33, 16, v33
    v_lshlrev_b32 v34, 16, v34
    v_lshlrev_b32 v35, 16, v35
    v_mul_f32 v112, 0xbfb8aa3b, v32
    v_mul_f32 v113, 0xbfb8aa3b, v33
    v_mul_f32 v114, 0xbfb8aa3b, v34
    v_mul_f32 v115, 0xbfb8aa3b, v35
    v_exp_f32 v112, v112
    v_exp_f32 v113, v113
    global_load_dwordx4 v[228:231], v107, s[4:5] offset:1024
    v_exp_f32 v114, v114
    v_exp_f32 v115, v115
    v_lshlrev_b32 v64, 16, v16
    v_and_b32 v65, 0xffff0000, v16
    v_lshlrev_b32 v66, 16, v17
    v_and_b32 v67, 0xffff0000, v17
    v_lshlrev_b32 v68, 16, v18
    v_and_b32 v69, 0xffff0000, v18
    global_load_dwordx4 v[232:235], v107, s[4:5] offset:2048
    v_lshlrev_b32 v70, 16, v19
    v_and_b32 v71, 0xffff0000, v19
    v_add_f32 v112, 1.0, v112
    v_add_f32 v113, 1.0, v113
    v_add_f32 v114, 1.0, v114
    v_add_f32 v115, 1.0, v115
    v_rcp_f32 v112, v112
    v_rcp_f32 v113, v113
    global_load_dwordx4 v[236:239], v107, s[4:5] offset:3072
    v_rcp_f32 v114, v114
    v_rcp_f32 v115, v115
    v_lshlrev_b32 v72, 16, v20
    v_and_b32 v73, 0xffff0000, v20
    v_lshlrev_b32 v74, 16, v21
    v_and_b32 v75, 0xffff0000, v21
    v_lshlrev_b32 v76, 16, v22
    v_and_b32 v77, 0xffff0000, v22
    global_load_dwordx4 v[240:243], v108, s[4:5] offset:0
    v_lshlrev_b32 v78, 16, v23
    v_and_b32 v79, 0xffff0000, v23
    v_mul_f32 v32, v32, v112
    v_mul_f32 v33, v33, v113
    v_mul_f32 v34, v34, v114
    v_mul_f32 v35, v35, v115
    v_cvt_pk_bf16_f32 v112, v32, v33
    v_cvt_pk_bf16_f32 v113, v34, v35
    v_lshlrev_b32 v32, 16, v112
    v_and_b32 v33, 0xffff0000, v112
    global_load_dwordx4 v[244:247], v108, s[4:5] offset:1024
    v_lshlrev_b32 v34, 16, v113
    v_and_b32 v35, 0xffff0000, v113
    v_lshlrev_b32 v80, 16, v24
    v_and_b32 v81, 0xffff0000, v24
    v_lshlrev_b32 v82, 16, v25
    v_and_b32 v83, 0xffff0000, v25
    v_lshlrev_b32 v84, 16, v26
    v_and_b32 v85, 0xffff0000, v26
    v_lshlrev_b32 v86, 16, v27
    v_and_b32 v87, 0xffff0000, v27
    global_load_dwordx4 v[248:251], v108, s[4:5] offset:2048
    v_lshlrev_b32 v88, 16, v28
    v_and_b32 v89, 0xffff0000, v28
    v_lshlrev_b32 v90, 16, v29
    v_and_b32 v91, 0xffff0000, v29
    v_lshlrev_b32 v92, 16, v30
    v_and_b32 v93, 0xffff0000, v30
    v_lshlrev_b32 v94, 16, v31
    v_and_b32 v95, 0xffff0000, v31
    v_pk_mul_f32 v[64:65], v[64:65], v[32:33] op_sel_hi:[1,0]
    v_pk_mul_f32 v[66:67], v[66:67], v[32:33] op_sel_hi:[1,0]
    global_load_dwordx4 v[252:255], v108, s[4:5] offset:3072
    v_pk_mul_f32 v[68:69], v[68:69], v[32:33] op_sel_hi:[1,0]
    v_pk_mul_f32 v[70:71], v[70:71], v[32:33] op_sel_hi:[1,0]
    v_pk_fma_f32 v[64:65], v[72:73], v[32:33], v[64:65] op_sel:[0,1,0] op_sel_hi:[1,1,1]
    v_pk_fma_f32 v[66:67], v[74:75], v[32:33], v[66:67] op_sel:[0,1,0] op_sel_hi:[1,1,1]
    v_pk_fma_f32 v[68:69], v[76:77], v[32:33], v[68:69] op_sel:[0,1,0] op_sel_hi:[1,1,1]
    v_pk_fma_f32 v[70:71], v[78:79], v[32:33], v[70:71] op_sel:[0,1,0] op_sel_hi:[1,1,1]
    v_pk_fma_f32 v[64:65], v[80:81], v[34:35], v[64:65] op_sel_hi:[1,0,1]
    v_pk_fma_f32 v[66:67], v[82:83], v[34:35], v[66:67] op_sel_hi:[1,0,1]
    v_pk_fma_f32 v[68:69], v[84:85], v[34:35], v[68:69] op_sel_hi:[1,0,1]
    v_pk_fma_f32 v[70:71], v[86:87], v[34:35], v[70:71] op_sel_hi:[1,0,1]
    global_load_dword v63, v104, s[6:7]
    v_pk_fma_f32 v[64:65], v[88:89], v[34:35], v[64:65] op_sel:[0,1,0] op_sel_hi:[1,1,1]
    v_pk_fma_f32 v[66:67], v[90:91], v[34:35], v[66:67] op_sel:[0,1,0] op_sel_hi:[1,1,1]
    v_pk_fma_f32 v[68:69], v[92:93], v[34:35], v[68:69] op_sel:[0,1,0] op_sel_hi:[1,1,1]
    v_pk_fma_f32 v[70:71], v[94:95], v[34:35], v[70:71] op_sel:[0,1,0] op_sel_hi:[1,1,1]
    s_nop 0
    v_permlane32_swap_b32 v64, v68
    v_permlane32_swap_b32 v65, v69
    v_permlane32_swap_b32 v66, v70
    v_permlane32_swap_b32 v67, v71
    v_pk_add_f32 v[64:65], v[64:65], v[68:69]
    v_pk_add_f32 v[66:67], v[66:67], v[70:71]
    s_nop 1
    v_permlane16_swap_b32 v64, v66
    v_permlane16_swap_b32 v65, v67
    v_pk_add_f32 v[64:65], v[64:65], v[66:67]
    s_nop 1
    v_add_f32_dpp v64, v64, v64 row_ror:8 row_mask:0xf bank_mask:0xf
    v_add_f32_dpp v65, v65, v65 row_ror:8 row_mask:0xf bank_mask:0xf
    ds_write_b64 v96, v[64:65]
    s_waitcnt lgkmcnt(0)
    s_add_u32 s100, s100, 0x4001
    s_and_b32 s101, s100, 0xc000c000
    s_barrier
    ds_read_b128 v[16:19], v97
    ds_read_b128 v[20:23], v97 offset:256
    ds_read_b128 v[24:27], v97 offset:512
    ds_read_b128 v[28:31], v97 offset:768
    s_waitcnt lgkmcnt(0)
    v_pk_add_f32 v[16:17], v[16:17], v[20:21]
    v_pk_add_f32 v[18:19], v[18:19], v[22:23]
    v_pk_add_f32 v[24:25], v[24:25], v[28:29]
    v_pk_add_f32 v[26:27], v[26:27], v[30:31]
    v_pk_add_f32 v[16:17], v[16:17], v[24:25]
    v_pk_add_f32 v[18:19], v[18:19], v[26:27]
    v_bfi_b32 v16, 63, s100, v16
    v_bfi_b32 v17, 63, s100, v17
    v_bfi_b32 v18, 63, s100, v18
    v_bfi_b32 v19, 63, s100, v19
    s_mov_b64 exec, 0xffff
    buffer_store_dwordx4 v[16:19], v2, s[32:35], s47 offen sc1
    s_mov_b64 exec, -1
    v_mov_b32 v62, s100
    s_mov_b32 m0, 132096
    s_nop 0
    global_load_lds_dwordx4 v98, s[8:9]
    global_load_lds_dwordx4 v98, s[8:9] offset:1024
    s_mov_b32 exec_lo, 0xff
    s_mov_b32 exec_hi, 0xff
    buffer_store_dword v106, v105, s[32:35], s80 offen sc1
    s_mov_b64 exec, -1
    s_waitcnt vmcnt(20)
    v_lshlrev_b32 v64, 16, v192
    s_branch S_0
T_0:
    s_branch T_4
S_0:
    s_xor_b32 s98, s94, 0
    s_mul_i32 s91, s98, 98304
    s_lshl_b32 s98, s98, 12
    s_add_u32 s91, s91, s59
    s_add_u32 s98, s98, s95
    s_mov_b32 m0, s98
    s_nop 0
    buffer_load_dwordx4 v56, s[40:43], s91 offen offset:0 lds
    v_and_b32 v65, 0xffff0000, v192
    v_lshlrev_b32 v66, 16, v193
    v_and_b32 v67, 0xffff0000, v193
    v_lshlrev_b32 v68, 16, v194
    v_and_b32 v69, 0xffff0000, v194
    v_lshlrev_b32 v70, 16, v195
    v_and_b32 v71, 0xffff0000, v195
    s_waitcnt vmcnt(20)
    v_lshlrev_b32 v72, 16, v196
    v_and_b32 v73, 0xffff0000, v196
    v_lshlrev_b32 v74, 16, v197
    v_and_b32 v75, 0xffff0000, v197
    v_lshlrev_b32 v76, 16, v198
    buffer_load_dwordx4 v57, s[40:43], s91 offen offset:1024 lds
    v_and_b32 v77, 0xffff0000, v198
    v_lshlrev_b32 v78, 16, v199
    v_and_b32 v79, 0xffff0000, v199
    v_pk_add_f32 v[192:193], v[64:65], v[66:67]
    v_pk_add_f32 v[196:197], v[72:73], v[74:75]
    v_pk_mul_f32 v[194:195], v[64:65], v[64:65]
    v_pk_mul_f32 v[198:199], v[72:73], v[72:73]
    v_pk_add_f32 v[192:193], v[192:193], v[68:69]
    v_pk_add_f32 v[196:197], v[196:197], v[76:77]
    v_pk_fma_f32 v[194:195], v[66:67], v[66:67], v[194:195]
    v_pk_fma_f32 v[198:199], v[74:75], v[74:75], v[198:199]
    v_pk_add_f32 v[192:193], v[192:193], v[70:71]
    v_pk_add_f32 v[196:197], v[196:197], v[78:79]
    buffer_load_dwordx4 v58, s[40:43], s91 offen offset:2048 lds
    v_pk_fma_f32 v[194:195], v[68:69], v[68:69], v[194:195]
    v_pk_fma_f32 v[198:199], v[76:77], v[76:77], v[198:199]
    v_add_f32 v192, v192, v193
    v_add_f32 v196, v196, v197
    v_pk_fma_f32 v[194:195], v[70:71], v[70:71], v[194:195]
    v_pk_fma_f32 v[198:199], v[78:79], v[78:79], v[198:199]
    v_add_f32 v194, v194, v195
    v_add_f32 v198, v198, v199
    s_waitcnt vmcnt(21)
    v_lshlrev_b32 v80, 16, v200
    v_and_b32 v81, 0xffff0000, v200
    v_lshlrev_b32 v82, 16, v201
    v_and_b32 v83, 0xffff0000, v201
    buffer_load_dwordx4 v59, s[40:43], s91 offen offset:3072 lds
    v_lshlrev_b32 v84, 16, v202
    v_and_b32 v85, 0xffff0000, v202
    v_lshlrev_b32 v86, 16, v203
    v_and_b32 v87, 0xffff0000, v203
    s_waitcnt vmcnt(21)
    v_lshlrev_b32 v88, 16, v204
    v_and_b32 v89, 0xffff0000, v204
    v_lshlrev_b32 v90, 16, v205
    v_and_b32 v91, 0xffff0000, v205
    v_lshlrev_b32 v92, 16, v206
    v_and_b32 v93, 0xffff0000, v206
    v_lshlrev_b32 v94, 16, v207
    v_and_b32 v95, 0xffff0000, v207
    s_xor_b32 s98, s94, 1
    s_mul_i32 s91, s98, 98304
    s_lshl_b32 s98, s98, 12
    s_add_u32 s91, s91, s59
    s_add_u32 s98, s98, s95
    s_mov_b32 m0, s98
    s_nop 0
    buffer_load_dwordx4 v56, s[40:43], s91 offen offset:0 lds
    v_pk_add_f32 v[200:201], v[80:81], v[82:83]
    v_pk_add_f32 v[204:205], v[88:89], v[90:91]
    v_pk_mul_f32 v[202:203], v[80:81], v[80:81]
    v_pk_mul_f32 v[206:207], v[88:89], v[88:89]
    v_pk_add_f32 v[200:201], v[200:201], v[84:85]
    v_pk_add_f32 v[204:205], v[204:205], v[92:93]
    v_pk_fma_f32 v[202:203], v[82:83], v[82:83], v[202:203]
    v_pk_fma_f32 v[206:207], v[90:91], v[90:91], v[206:207]
    v_pk_add_f32 v[200:201], v[200:201], v[86:87]
    v_pk_add_f32 v[204:205], v[204:205], v[94:95]
    v_pk_fma_f32 v[202:203], v[84:85], v[84:85], v[202:203]
    v_pk_fma_f32 v[206:207], v[92:93], v[92:93], v[206:207]
    v_add_f32 v200, v200, v201
    buffer_load_dwordx4 v57, s[40:43], s91 offen offset:1024 lds
    v_add_f32 v204, v204, v205
    v_pk_fma_f32 v[202:203], v[86:87], v[86:87], v[202:203]
    v_pk_fma_f32 v[206:207], v[94:95], v[94:95], v[206:207]
    v_add_f32 v202, v202, v203
    v_add_f32 v206, v206, v207
    s_waitcnt vmcnt(22)
    v_lshlrev_b32 v96, 16, v208
    v_and_b32 v97, 0xffff0000, v208
    v_lshlrev_b32 v98, 16, v209
    v_and_b32 v99, 0xffff0000, v209
    v_lshlrev_b32 v100, 16, v210
    v_and_b32 v101, 0xffff0000, v210
    v_lshlrev_b32 v102, 16, v211
    buffer_load_dwordx4 v58, s[40:43], s91 offen offset:2048 lds
    v_and_b32 v103, 0xffff0000, v211
    s_waitcnt vmcnt(22)
    v_lshlrev_b32 v104, 16, v212
    v_and_b32 v105, 0xffff0000, v212
    v_lshlrev_b32 v106, 16, v213
    v_and_b32 v107, 0xffff0000, v213
    v_lshlrev_b32 v108, 16, v214
    v_and_b32 v109, 0xffff0000, v214
    v_lshlrev_b32 v110, 16, v215
    v_and_b32 v111, 0xffff0000, v215
    v_pk_add_f32 v[208:209], v[96:97], v[98:99]
    v_pk_add_f32 v[212:213], v[104:105], v[106:107]
    v_pk_mul_f32 v[210:211], v[96:97], v[96:97]
    buffer_load_dwordx4 v59, s[40:43], s91 offen offset:3072 lds
    v_pk_mul_f32 v[214:215], v[104:105], v[104:105]
    v_pk_add_f32 v[208:209], v[208:209], v[100:101]
    v_pk_add_f32 v[212:213], v[212:213], v[108:109]
    v_pk_fma_f32 v[210:211], v[98:99], v[98:99], v[210:211]
    v_pk_fma_f32 v[214:215], v[106:107], v[106:107], v[214:215]
    v_pk_add_f32 v[208:209], v[208:209], v[102:103]
    v_pk_add_f32 v[212:213], v[212:213], v[110:111]
    v_pk_fma_f32 v[210:211], v[100:101], v[100:101], v[210:211]
    v_pk_fma_f32 v[214:215], v[108:109], v[108:109], v[214:215]
    v_add_f32 v208, v208, v209
    v_add_f32 v212, v212, v213
    v_pk_fma_f32 v[210:211], v[102:103], v[102:103], v[210:211]
    v_pk_fma_f32 v[214:215], v[110:111], v[110:111], v[214:215]
    s_xor_b32 s98, s94, 2
    s_mul_i32 s91, s98, 98304
    s_lshl_b32 s98, s98, 12
    s_add_u32 s91, s91, s59
    s_add_u32 s98, s98, s95
    s_mov_b32 m0, s98
    s_nop 0
    buffer_load_dwordx4 v56, s[40:43], s91 offen offset:0 lds
    v_add_f32 v210, v210, v211
    v_add_f32 v214, v214, v215
    s_waitcnt vmcnt(23)
    v_lshlrev_b32 v112, 16, v216
    v_and_b32 v113, 0xffff0000, v216
    v_lshlrev_b32 v114, 16, v217
    v_and_b32 v115, 0xffff0000, v217
    v_lshlrev_b32 v116, 16, v218
    v_and_b32 v117, 0xffff0000, v218
    v_lshlrev_b32 v118, 16, v219
    v_and_b32 v119, 0xffff0000, v219
    s_waitcnt vmcnt(22)
    v_lshlrev_b32 v120, 16, v220
    buffer_load_dwordx4 v57, s[40:43], s91 offen offset:1024 lds
    v_and_b32 v121, 0xffff0000, v220
    v_lshlrev_b32 v122, 16, v221
    v_and_b32 v123, 0xffff0000, v221
    v_lshlrev_b32 v124, 16, v222
    v_and_b32 v125, 0xffff0000, v222
    v_lshlrev_b32 v126, 16, v223
    v_and_b32 v127, 0xffff0000, v223
    v_pk_add_f32 v[216:217], v[112:113], v[114:115]
    v_pk_add_f32 v[220:221], v[120:121], v[122:123]
    v_pk_mul_f32 v[218:219], v[112:113], v[112:113]
    v_pk_mul_f32 v[222:223], v[120:121], v[120:121]
    v_pk_add_f32 v[216:217], v[216:217], v[116:117]
    v_pk_add_f32 v[220:221], v[220:221], v[124:125]
    buffer_load_dwordx4 v58, s[40:43], s91 offen offset:2048 lds
    v_pk_fma_f32 v[218:219], v[114:115], v[114:115], v[218:219]
    v_pk_fma_f32 v[222:223], v[122:123], v[122:123], v[222:223]
    v_pk_add_f32 v[216:217], v[216:217], v[118:119]
    v_pk_add_f32 v[220:221], v[220:221], v[126:127]
    v_pk_fma_f32 v[218:219], v[116:117], v[116:117], v[218:219]
    v_pk_fma_f32 v[222:223], v[124:125], v[124:125], v[222:223]
    v_add_f32 v216, v216, v217
    v_add_f32 v220, v220, v221
    v_pk_fma_f32 v[218:219], v[118:119], v[118:119], v[218:219]
    v_pk_fma_f32 v[222:223], v[126:127], v[126:127], v[222:223]
    v_add_f32 v218, v218, v219
    v_add_f32 v222, v222, v223
    s_waitcnt vmcnt(23)
    v_lshlrev_b32 v128, 16, v224
    buffer_load_dwordx4 v59, s[40:43], s91 offen offset:3072 lds
    v_and_b32 v129, 0xffff0000, v224
    v_lshlrev_b32 v130, 16, v225
    v_and_b32 v131, 0xffff0000, v225
    v_lshlrev_b32 v132, 16, v226
    v_and_b32 v133, 0xffff0000, v226
    v_lshlrev_b32 v134, 16, v227
    v_and_b32 v135, 0xffff0000, v227
    s_waitcnt vmcnt(23)
    v_lshlrev_b32 v136, 16, v228
    v_and_b32 v137, 0xffff0000, v228
    v_lshlrev_b32 v138, 16, v229
    v_and_b32 v139, 0xffff0000, v229
    v_lshlrev_b32 v140, 16, v230
    s_xor_b32 s98, s94, 3
    s_mul_i32 s91, s98, 98304
    s_lshl_b32 s98, s98, 12
    s_add_u32 s91, s91, s59
    s_add_u32 s98, s98, s95
    s_mov_b32 m0, s98
    s_nop 0
    buffer_load_dwordx4 v56, s[40:43], s91 offen offset:0 lds
    v_and_b32 v141, 0xffff0000, v230
    v_lshlrev_b32 v142, 16, v231
    v_and_b32 v143, 0xffff0000, v231
    v_pk_add_f32 v[224:225], v[128:129], v[130:131]
    v_pk_add_f32 v[228:229], v[136:137], v[138:139]
    v_pk_mul_f32 v[226:227], v[128:129], v[128:129]
    v_pk_mul_f32 v[230:231], v[136:137], v[136:137]
    v_pk_add_f32 v[224:225], v[224:225], v[132:133]
    v_pk_add_f32 v[228:229], v[228:229], v[140:141]
    v_pk_fma_f32 v[226:227], v[130:131], v[130:131], v[226:227]
    v_pk_fma_f32 v[230:231], v[138:139], v[138:139], v[230:231]
    v_pk_add_f32 v[224:225], v[224:225], v[134:135]
    v_pk_add_f32 v[228:229], v[228:229], v[142:143]
    buffer_load_dwordx4 v57, s[40:43], s91 offen offset:1024 lds
    v_pk_fma_f32 v[226:227], v[132:133], v[132:133], v[226:227]
    v_pk_fma_f32 v[230:231], v[140:141], v[140:141], v[230:231]
    v_add_f32 v224, v224, v225
    v_add_f32 v228, v228, v229
    v_pk_fma_f32 v[226:227], v[134:135], v[134:135], v[226:227]
    v_pk_fma_f32 v[230:231], v[142:143], v[142:143], v[230:231]
    v_add_f32 v226, v226, v227
    v_add_f32 v230, v230, v231
    s_waitcnt vmcnt(24)
    v_lshlrev_b32 v144, 16, v232
    v_and_b32 v145, 0xffff0000, v232
    v_lshlrev_b32 v146, 16, v233
    v_and_b32 v147, 0xffff0000, v233
    buffer_load_dwordx4 v58, s[40:43], s91 offen offset:2048 lds
    v_lshlrev_b32 v148, 16, v234
    v_and_b32 v149, 0xffff0000, v234
    v_lshlrev_b32 v150, 16, v235
    v_and_b32 v151, 0xffff0000, v235
    s_waitcnt vmcnt(24)
    v_lshlrev_b32 v152, 16, v236
    v_and_b32 v153, 0xffff0000, v236
    v_lshlrev_b32 v154, 16, v237
    v_and_b32 v155, 0xffff0000, v237
    v_lshlrev_b32 v156, 16, v238
    v_and_b32 v157, 0xffff0000, v238
    v_lshlrev_b32 v158, 16, v239
    v_and_b32 v159, 0xffff0000, v239
    buffer_load_dwordx4 v59, s[40:43], s91 offen offset:3072 lds
    v_pk_add_f32 v[232:233], v[144:145], v[146:147]
    v_pk_add_f32 v[236:237], v[152:153], v[154:155]
    v_pk_mul_f32 v[234:235], v[144:145], v[144:145]
    v_pk_mul_f32 v[238:239], v[152:153], v[152:153]
    v_pk_add_f32 v[232:233], v[232:233], v[148:149]
    v_pk_add_f32 v[236:237], v[236:237], v[156:157]
    v_pk_fma_f32 v[234:235], v[146:147], v[146:147], v[234:235]
    v_pk_fma_f32 v[238:239], v[154:155], v[154:155], v[238:239]
    v_pk_add_f32 v[232:233], v[232:233], v[150:151]
    v_pk_add_f32 v[236:237], v[236:237], v[158:159]
    v_pk_fma_f32 v[234:235], v[148:149], v[148:149], v[234:235]
    v_pk_fma_f32 v[238:239], v[156:157], v[156:157], v[238:239]
    v_add_f32 v232, v232, v233
    s_xor_b32 s98, s94, 4
    s_mul_i32 s91, s98, 98304
    s_lshl_b32 s98, s98, 12
    s_add_u32 s91, s91, s59
    s_add_u32 s98, s98, s95
    s_mov_b32 m0, s98
    s_nop 0
    buffer_load_dwordx4 v56, s[40:43], s91 offen offset:0 lds
    v_add_f32 v236, v236, v237
    v_pk_fma_f32 v[234:235], v[150:151], v[150:151], v[234:235]
    v_pk_fma_f32 v[238:239], v[158:159], v[158:159], v[238:239]
    v_add_f32 v234, v234, v235
    v_add_f32 v238, v238, v239
    s_waitcnt vmcnt(25)
    v_lshlrev_b32 v160, 16, v240
    v_and_b32 v161, 0xffff0000, v240
    v_lshlrev_b32 v162, 16, v241
    v_and_b32 v163, 0xffff0000, v241
    v_lshlrev_b32 v164, 16, v242
    v_and_b32 v165, 0xffff0000, v242
    v_lshlrev_b32 v166, 16, v243
    buffer_load_dwordx4 v57, s[40:43], s91 offen offset:1024 lds
    v_and_b32 v167, 0xffff0000, v243
    s_waitcnt vmcnt(25)
    v_lshlrev_b32 v168, 16, v244
    v_and_b32 v169, 0xffff0000, v244
    v_lshlrev_b32 v170, 16, v245
    v_and_b32 v171, 0xffff0000, v245
    v_lshlrev_b32 v172, 16, v246
    v_and_b32 v173, 0xffff0000, v246
    v_lshlrev_b32 v174, 16, v247
    v_and_b32 v175, 0xffff0000, v247
    v_pk_add_f32 v[240:241], v[160:161], v[162:163]
    v_pk_add_f32 v[244:245], v[168:169], v[170:171]
    v_pk_mul_f32 v[242:243], v[160:161], v[160:161]
    buffer_load_dwordx4 v58, s[40:43], s91 offen offset:2048 lds
    v_pk_mul_f32 v[246:247], v[168:169], v[168:169]
    v_pk_add_f32 v[240:241], v[240:241], v[164:165]
    v_pk_add_f32 v[244:245], v[244:245], v[172:173]
    v_pk_fma_f32 v[242:243], v[162:163], v[162:163], v[242:243]
    v_pk_fma_f32 v[246:247], v[170:171], v[170:171], v[246:247]
    v_pk_add_f32 v[240:241], v[240:241], v[166:167]
    v_pk_add_f32 v[244:245], v[244:245], v[174:175]
    v_pk_fma_f32 v[242:243], v[164:165], v[164:165], v[242:243]
    v_pk_fma_f32 v[246:247], v[172:173], v[172:173], v[246:247]
    v_add_f32 v240, v240, v241
    v_add_f32 v244, v244, v245
    v_pk_fma_f32 v[242:243], v[166:167], v[166:167], v[242:243]
    v_pk_fma_f32 v[246:247], v[174:175], v[174:175], v[246:247]
    buffer_load_dwordx4 v59, s[40:43], s91 offen offset:3072 lds
    v_add_f32 v242, v242, v243
    v_add_f32 v246, v246, v247
    s_waitcnt vmcnt(26)
    v_lshlrev_b32 v176, 16, v248
    v_and_b32 v177, 0xffff0000, v248
    v_lshlrev_b32 v178, 16, v249
    v_and_b32 v179, 0xffff0000, v249
    v_lshlrev_b32 v180, 16, v250
    v_and_b32 v181, 0xffff0000, v250
    v_lshlrev_b32 v182, 16, v251
    v_and_b32 v183, 0xffff0000, v251
    s_waitcnt vmcnt(25)
    v_lshlrev_b32 v184, 16, v252
    s_xor_b32 s98, s94, 5
    s_mul_i32 s91, s98, 98304
    s_lshl_b32 s98, s98, 12
    s_add_u32 s91, s91, s59
    s_add_u32 s98, s98, s95
    s_mov_b32 m0, s98
    s_nop 0
    buffer_load_dwordx4 v56, s[40:43], s91 offen offset:0 lds
    v_and_b32 v185, 0xffff0000, v252
    v_lshlrev_b32 v186, 16, v253
    v_and_b32 v187, 0xffff0000, v253
    v_lshlrev_b32 v188, 16, v254
    v_and_b32 v189, 0xffff0000, v254
    v_lshlrev_b32 v190, 16, v255
    v_and_b32 v191, 0xffff0000, v255
    v_pk_add_f32 v[248:249], v[176:177], v[178:179]
    v_pk_add_f32 v[252:253], v[184:185], v[186:187]
    v_pk_mul_f32 v[250:251], v[176:177], v[176:177]
    v_pk_mul_f32 v[254:255], v[184:185], v[184:185]
    v_pk_add_f32 v[248:249], v[248:249], v[180:181]
    v_pk_add_f32 v[252:253], v[252:253], v[188:189]
    buffer_load_dwordx4 v57, s[40:43], s91 offen offset:1024 lds
    v_pk_fma_f32 v[250:251], v[178:179], v[178:179], v[250:251]
    v_pk_fma_f32 v[254:255], v[186:187], v[186:187], v[254:255]
    v_pk_add_f32 v[248:249], v[248:249], v[182:183]
    v_pk_add_f32 v[252:253], v[252:253], v[190:191]
    v_pk_fma_f32 v[250:251], v[180:181], v[180:181], v[250:251]
    v_pk_fma_f32 v[254:255], v[188:189], v[188:189], v[254:255]
    v_add_f32 v248, v248, v249
    v_add_f32 v252, v252, v253
    v_pk_fma_f32 v[250:251], v[182:183], v[182:183], v[250:251]
    v_pk_fma_f32 v[254:255], v[190:191], v[190:191], v[254:255]
    v_add_f32 v250, v250, v251
    v_add_f32 v254, v254, v255
    v_permlane32_swap_b32 v192, v224
    buffer_load_dwordx4 v58, s[40:43], s91 offen offset:2048 lds
    v_permlane32_swap_b32 v194, v226
    v_permlane32_swap_b32 v196, v228
    v_permlane32_swap_b32 v198, v230
    v_permlane32_swap_b32 v200, v232
    v_permlane32_swap_b32 v202, v234
    v_permlane32_swap_b32 v204, v236
    v_permlane32_swap_b32 v206, v238
    v_permlane32_swap_b32 v208, v240
    v_permlane32_swap_b32 v210, v242
    v_permlane32_swap_b32 v212, v244
    v_permlane32_swap_b32 v214, v246
    v_permlane32_swap_b32 v216, v248
    v_permlane32_swap_b32 v218, v250
    buffer_load_dwordx4 v59, s[40:43], s91 offen offset:3072 lds
    v_permlane32_swap_b32 v220, v252
    v_permlane32_swap_b32 v222, v254
    v_add_f32 v192, v192, v224
    v_add_f32 v194, v194, v226
    v_add_f32 v196, v196, v228
    v_add_f32 v198, v198, v230
    v_add_f32 v200, v200, v232
    v_add_f32 v202, v202, v234
    v_add_f32 v204, v204, v236
    v_add_f32 v206, v206, v238
    v_add_f32 v208, v208, v240
    v_add_f32 v210, v210, v242
    v_add_f32 v212, v212, v244
    s_xor_b32 s98, s94, 6
    s_mul_i32 s91, s98, 98304
    s_lshl_b32 s98, s98, 12
    s_add_u32 s91, s91, s59
    s_add_u32 s98, s98, s95
    s_mov_b32 m0, s98
    s_nop 0
    buffer_load_dwordx4 v56, s[40:43], s91 offen offset:0 lds
    v_add_f32 v214, v214, v246
    v_add_f32 v216, v216, v248
    v_add_f32 v218, v218, v250
    v_add_f32 v220, v220, v252
    v_add_f32 v222, v222, v254
    v_permlane16_swap_b32 v192, v208
    v_permlane16_swap_b32 v194, v210
    v_permlane16_swap_b32 v196, v212
    v_permlane16_swap_b32 v198, v214
    v_permlane16_swap_b32 v200, v216
    v_permlane16_swap_b32 v202, v218
    v_permlane16_swap_b32 v204, v220
    v_permlane16_swap_b32 v206, v222
    buffer_load_dwordx4 v57, s[40:43], s91 offen offset:1024 lds
    v_add_f32 v192, v192, v208
    v_add_f32 v194, v194, v210
    v_add_f32 v196, v196, v212
    v_add_f32 v198, v198, v214
    v_add_f32 v200, v200, v216
    v_add_f32 v202, v202, v218
    v_add_f32 v204, v204, v220
    v_add_f32 v206, v206, v222
    v_add_f32_dpp v192, v192, v192 row_ror:8 row_mask:0xf bank_mask:3
    v_add_f32_dpp v194, v194, v194 row_ror:8 row_mask:0xf bank_mask:3
    v_add_f32_dpp v196, v196, v196 row_ror:8 row_mask:0xf bank_mask:3
    v_add_f32_dpp v198, v198, v198 row_ror:8 row_mask:0xf bank_mask:3
    v_add_f32_dpp v192, v200, v200 row_ror:8 row_mask:0xf bank_mask:12
    buffer_load_dwordx4 v58, s[40:43], s91 offen offset:2048 lds
    v_add_f32_dpp v194, v202, v202 row_ror:8 row_mask:0xf bank_mask:12
    v_add_f32_dpp v196, v204, v204 row_ror:8 row_mask:0xf bank_mask:12
    v_add_f32_dpp v198, v206, v206 row_ror:8 row_mask:0xf bank_mask:12
    v_add_f32_dpp v192, v192, v192 row_half_mirror row_mask:0xf bank_mask:5
    v_add_f32_dpp v194, v194, v194 row_half_mirror row_mask:0xf bank_mask:5
    s_nop 0
    v_add_f32_dpp v192, v196, v196 row_half_mirror row_mask:0xf bank_mask:10
    v_add_f32_dpp v194, v198, v198 row_half_mirror row_mask:0xf bank_mask:10
    s_nop 0
    v_add_f32_dpp v192, v192, v192 quad_perm:[1,0,3,2] row_mask:0xf bank_mask:0xf
    v_add_f32_dpp v194, v194, v194 quad_perm:[1,0,3,2] row_mask:0xf bank_mask:0xf
    s_nop 0
    v_add_f32_dpp v192, v192, v192 quad_perm:[2,3,0,1] row_mask:0xf bank_mask:0xf
    buffer_load_dwordx4 v59, s[40:43], s91 offen offset:3072 lds
    v_add_f32_dpp v194, v194, v194 quad_perm:[2,3,0,1] row_mask:0xf bank_mask:0xf
    v_mul_f32 v192, 0xbb000000, v192
    v_mov_b32 v193, 0x3727c5ac
    v_fmamk_f32 v194, v194, 0x3b000000, v193
    v_fma_f32 v194, -v192, v192, v194
    v_max_f32 v194, v194, v193
    v_rsq_f32 v194, v194
    v_mov_b32 v252, -1
    v_mul_f32 v192, v192, v194
    v_mov_b32 v253, -1
    v_mov_b32 v254, -1
    v_mov_b32 v255, -1
    s_xor_b32 s98, s94, 7
    s_mul_i32 s91, s98, 98304
    s_lshl_b32 s98, s98, 12
    s_add_u32 s91, s91, s59
    s_add_u32 s98, s98, s95
    s_mov_b32 m0, s98
    s_nop 0
    buffer_load_dwordx4 v56, s[40:43], s91 offen offset:0 lds
    v_readlane_b32 s64, v194, 0
    v_readlane_b32 s65, v192, 0
    v_readlane_b32 s66, v194, 4
    v_readlane_b32 s67, v192, 4
    v_readlane_b32 s68, v194, 8
    v_readlane_b32 s69, v192, 8
    v_readlane_b32 s70, v194, 12
    v_readlane_b32 s71, v192, 12
    v_readlane_b32 s72, v194, 16
    v_readlane_b32 s73, v192, 16
    v_readlane_b32 s74, v194, 20
    v_readlane_b32 s75, v192, 20
    v_readlane_b32 s76, v194, 24
    buffer_load_dwordx4 v57, s[40:43], s91 offen offset:1024 lds
    v_readlane_b32 s77, v192, 24
    v_readlane_b32 s78, v194, 28
    v_readlane_b32 s79, v192, 28
    v_pk_fma_f32 v[64:65], v[64:65], s[64:65], s[64:65] op_sel:[0,0,1] op_sel_hi:[1,0,1]
    v_pk_fma_f32 v[66:67], v[66:67], s[64:65], s[64:65] op_sel:[0,0,1] op_sel_hi:[1,0,1]
    v_pk_fma_f32 v[68:69], v[68:69], s[64:65], s[64:65] op_sel:[0,0,1] op_sel_hi:[1,0,1]
    v_pk_fma_f32 v[70:71], v[70:71], s[64:65], s[64:65] op_sel:[0,0,1] op_sel_hi:[1,0,1]
    v_pk_fma_f32 v[72:73], v[72:73], s[66:67], s[66:67] op_sel:[0,0,1] op_sel_hi:[1,0,1]
    v_pk_fma_f32 v[74:75], v[74:75], s[66:67], s[66:67] op_sel:[0,0,1] op_sel_hi:[1,0,1]
    v_pk_fma_f32 v[76:77], v[76:77], s[66:67], s[66:67] op_sel:[0,0,1] op_sel_hi:[1,0,1]
    v_pk_fma_f32 v[78:79], v[78:79], s[66:67], s[66:67] op_sel:[0,0,1] op_sel_hi:[1,0,1]
    v_pk_fma_f32 v[80:81], v[80:81], s[68:69], s[68:69] op_sel:[0,0,1] op_sel_hi:[1,0,1]
    v_pk_fma_f32 v[82:83], v[82:83], s[68:69], s[68:69] op_sel:[0,0,1] op_sel_hi:[1,0,1]
    buffer_load_dwordx4 v58, s[40:43], s91 offen offset:2048 lds
    v_pk_fma_f32 v[84:85], v[84:85], s[68:69], s[68:69] op_sel:[0,0,1] op_sel_hi:[1,0,1]
    v_pk_fma_f32 v[86:87], v[86:87], s[68:69], s[68:69] op_sel:[0,0,1] op_sel_hi:[1,0,1]
    v_pk_fma_f32 v[88:89], v[88:89], s[70:71], s[70:71] op_sel:[0,0,1] op_sel_hi:[1,0,1]
    v_pk_fma_f32 v[90:91], v[90:91], s[70:71], s[70:71] op_sel:[0,0,1] op_sel_hi:[1,0,1]
    v_pk_fma_f32 v[92:93], v[92:93], s[70:71], s[70:71] op_sel:[0,0,1] op_sel_hi:[1,0,1]
    v_pk_fma_f32 v[94:95], v[94:95], s[70:71], s[70:71] op_sel:[0,0,1] op_sel_hi:[1,0,1]
    v_pk_fma_f32 v[96:97], v[96:97], s[72:73], s[72:73] op_sel:[0,0,1] op_sel_hi:[1,0,1]
    v_pk_fma_f32 v[98:99], v[98:99], s[72:73], s[72:73] op_sel:[0,0,1] op_sel_hi:[1,0,1]
    v_pk_fma_f32 v[100:101], v[100:101], s[72:73], s[72:73] op_sel:[0,0,1] op_sel_hi:[1,0,1]
    v_pk_fma_f32 v[102:103], v[102:103], s[72:73], s[72:73] op_sel:[0,0,1] op_sel_hi:[1,0,1]
    v_pk_fma_f32 v[104:105], v[104:105], s[74:75], s[74:75] op_sel:[0,0,1] op_sel_hi:[1,0,1]
    v_pk_fma_f32 v[106:107], v[106:107], s[74:75], s[74:75] op_sel:[0,0,1] op_sel_hi:[1,0,1]
    v_pk_fma_f32 v[108:109], v[108:109], s[74:75], s[74:75] op_sel:[0,0,1] op_sel_hi:[1,0,1]
    buffer_load_dwordx4 v59, s[40:43], s91 offen offset:3072 lds
    v_pk_fma_f32 v[110:111], v[110:111], s[74:75], s[74:75] op_sel:[0,0,1] op_sel_hi:[1,0,1]
    v_pk_fma_f32 v[112:113], v[112:113], s[76:77], s[76:77] op_sel:[0,0,1] op_sel_hi:[1,0,1]
    v_pk_fma_f32 v[114:115], v[114:115], s[76:77], s[76:77] op_sel:[0,0,1] op_sel_hi:[1,0,1]
    v_pk_fma_f32 v[116:117], v[116:117], s[76:77], s[76:77] op_sel:[0,0,1] op_sel_hi:[1,0,1]
    v_pk_fma_f32 v[118:119], v[118:119], s[76:77], s[76:77] op_sel:[0,0,1] op_sel_hi:[1,0,1]
    v_pk_fma_f32 v[120:121], v[120:121], s[78:79], s[78:79] op_sel:[0,0,1] op_sel_hi:[1,0,1]
    v_pk_fma_f32 v[122:123], v[122:123], s[78:79], s[78:79] op_sel:[0,0,1] op_sel_hi:[1,0,1]
    v_pk_fma_f32 v[124:125], v[124:125], s[78:79], s[78:79] op_sel:[0,0,1] op_sel_hi:[1,0,1]
    v_pk_fma_f32 v[126:127], v[126:127], s[78:79], s[78:79] op_sel:[0,0,1] op_sel_hi:[1,0,1]
    v_readlane_b32 s64, v194, 32
    v_readlane_b32 s65, v192, 32
    v_readlane_b32 s66, v194, 36
    v_readlane_b32 s67, v192, 36
    buffer_load_dwordx4 v[16:19], v2, s[32:35], s12 offen sc1
    buffer_load_dwordx4 v[20:23], v2, s[32:35], s13 offen sc1
    buffer_load_dwordx4 v[24:27], v2, s[32:35], s14 offen sc1
    buffer_load_dwordx4 v[28:31], v2, s[32:35], s15 offen sc1
    buffer_load_dwordx4 v[32:35], v12, s[32:35], s52 offen sc1
    v_readlane_b32 s68, v194, 40
    v_readlane_b32 s69, v192, 40
    v_readlane_b32 s70, v194, 44
    v_readlane_b32 s71, v192, 44
    v_readlane_b32 s72, v194, 48
    v_readlane_b32 s73, v192, 48
    v_readlane_b32 s74, v194, 52
    v_readlane_b32 s75, v192, 52
    v_readlane_b32 s76, v194, 56
    v_readlane_b32 s77, v192, 56
    v_readlane_b32 s78, v194, 60
    v_readlane_b32 s79, v192, 60
    v_pk_fma_f32 v[128:129], v[128:129], s[64:65], s[64:65] op_sel:[0,0,1] op_sel_hi:[1,0,1]
    v_pk_fma_f32 v[130:131], v[130:131], s[64:65], s[64:65] op_sel:[0,0,1] op_sel_hi:[1,0,1]
    v_pk_fma_f32 v[132:133], v[132:133], s[64:65], s[64:65] op_sel:[0,0,1] op_sel_hi:[1,0,1]
    v_pk_fma_f32 v[134:135], v[134:135], s[64:65], s[64:65] op_sel:[0,0,1] op_sel_hi:[1,0,1]
    v_pk_fma_f32 v[136:137], v[136:137], s[66:67], s[66:67] op_sel:[0,0,1] op_sel_hi:[1,0,1]
    v_pk_fma_f32 v[138:139], v[138:139], s[66:67], s[66:67] op_sel:[0,0,1] op_sel_hi:[1,0,1]
    v_pk_fma_f32 v[140:141], v[140:141], s[66:67], s[66:67] op_sel:[0,0,1] op_sel_hi:[1,0,1]
    v_pk_fma_f32 v[142:143], v[142:143], s[66:67], s[66:67] op_sel:[0,0,1] op_sel_hi:[1,0,1]
    v_pk_fma_f32 v[144:145], v[144:145], s[68:69], s[68:69] op_sel:[0,0,1] op_sel_hi:[1,0,1]
    v_pk_fma_f32 v[146:147], v[146:147], s[68:69], s[68:69] op_sel:[0,0,1] op_sel_hi:[1,0,1]
    v_pk_fma_f32 v[148:149], v[148:149], s[68:69], s[68:69] op_sel:[0,0,1] op_sel_hi:[1,0,1]
    v_pk_fma_f32 v[150:151], v[150:151], s[68:69], s[68:69] op_sel:[0,0,1] op_sel_hi:[1,0,1]
    v_pk_fma_f32 v[152:153], v[152:153], s[70:71], s[70:71] op_sel:[0,0,1] op_sel_hi:[1,0,1]
    v_pk_fma_f32 v[154:155], v[154:155], s[70:71], s[70:71] op_sel:[0,0,1] op_sel_hi:[1,0,1]
    v_pk_fma_f32 v[156:157], v[156:157], s[70:71], s[70:71] op_sel:[0,0,1] op_sel_hi:[1,0,1]
    v_pk_fma_f32 v[158:159], v[158:159], s[70:71], s[70:71] op_sel:[0,0,1] op_sel_hi:[1,0,1]
    v_pk_fma_f32 v[160:161], v[160:161], s[72:73], s[72:73] op_sel:[0,0,1] op_sel_hi:[1,0,1]
    v_pk_fma_f32 v[162:163], v[162:163], s[72:73], s[72:73] op_sel:[0,0,1] op_sel_hi:[1,0,1]
    v_pk_fma_f32 v[164:165], v[164:165], s[72:73], s[72:73] op_sel:[0,0,1] op_sel_hi:[1,0,1]
    v_pk_fma_f32 v[166:167], v[166:167], s[72:73], s[72:73] op_sel:[0,0,1] op_sel_hi:[1,0,1]
    v_pk_fma_f32 v[168:169], v[168:169], s[74:75], s[74:75] op_sel:[0,0,1] op_sel_hi:[1,0,1]
    v_pk_fma_f32 v[170:171], v[170:171], s[74:75], s[74:75] op_sel:[0,0,1] op_sel_hi:[1,0,1]
    v_pk_fma_f32 v[172:173], v[172:173], s[74:75], s[74:75] op_sel:[0,0,1] op_sel_hi:[1,0,1]
    v_pk_fma_f32 v[174:175], v[174:175], s[74:75], s[74:75] op_sel:[0,0,1] op_sel_hi:[1,0,1]
    v_pk_fma_f32 v[176:177], v[176:177], s[76:77], s[76:77] op_sel:[0,0,1] op_sel_hi:[1,0,1]
    v_pk_fma_f32 v[178:179], v[178:179], s[76:77], s[76:77] op_sel:[0,0,1] op_sel_hi:[1,0,1]
    v_pk_fma_f32 v[180:181], v[180:181], s[76:77], s[76:77] op_sel:[0,0,1] op_sel_hi:[1,0,1]
    v_pk_fma_f32 v[182:183], v[182:183], s[76:77], s[76:77] op_sel:[0,0,1] op_sel_hi:[1,0,1]
    v_pk_fma_f32 v[184:185], v[184:185], s[78:79], s[78:79] op_sel:[0,0,1] op_sel_hi:[1,0,1]
    v_pk_fma_f32 v[186:187], v[186:187], s[78:79], s[78:79] op_sel:[0,0,1] op_sel_hi:[1,0,1]
    v_pk_fma_f32 v[188:189], v[188:189], s[78:79], s[78:79] op_sel:[0,0,1] op_sel_hi:[1,0,1]
    v_pk_fma_f32 v[190:191], v[190:191], s[78:79], s[78:79] op_sel:[0,0,1] op_sel_hi:[1,0,1]
    s_mov_b32 exec_hi, s1
    s_add_u32 m0, s48, 0
    s_nop 0
    buffer_load_dwordx4 v2, s[36:39], s49 offen lds
    s_add_u32 m0, s48, 704
    s_add_u32 s49, s49, s50
    buffer_load_dwordx4 v2, s[36:39], s49 offen lds
    s_mov_b32 exec_hi, -1
    s_mov_b32 exec_hi, s1
    s_add_u32 m0, s48, 1408
    s_add_u32 s49, s49, s50
    buffer_load_dwordx4 v2, s[36:39], s49 offen lds
    s_add_u32 m0, s48, 2112
    s_add_u32 s49, s49, s50
    buffer_load_dwordx4 v2, s[36:39], s49 offen lds
    s_mov_b32 exec_hi, -1
    s_mov_b32 exec_hi, s1
    s_add_u32 m0, s48, 2816
    s_add_u32 s49, s49, s50
    buffer_load_dwordx4 v2, s[36:39], s49 offen lds
    s_add_u32 m0, s48, 3520
    s_add_u32 s49, s49, s50
    buffer_load_dwordx4 v2, s[36:39], s49 offen lds
    s_mov_b32 exec_hi, -1
    s_mov_b32 exec_hi, s1
    s_add_u32 m0, s48, 4224
    s_add_u32 s49, s49, s50
    buffer_load_dwordx4 v2, s[36:39], s49 offen lds
    s_add_u32 m0, s48, 4928
    s_add_u32 s49, s49, s50
    buffer_load_dwordx4 v2, s[36:39], s49 offen lds
    s_mov_b32 exec_hi, -1
    s_waitcnt vmcnt(13)
    s_waitcnt lgkmcnt(0)
    s_barrier
    ds_read_b64_tr_b16 v[48:49], v37
    ds_read_b64_tr_b16 v[50:51], v37 offset:128
    ds_read_b64_tr_b16 v[52:53], v38
    ds_read_b64_tr_b16 v[54:55], v38 offset:128
    ds_read_b64_tr_b16 v[56:57], v38 offset:512
    ds_read_b64_tr_b16 v[58:59], v38 offset:640
    ds_read_b64_tr_b16 a[0:1], v36 offset:0
    ds_read_b64_tr_b16 a[2:3], v36 offset:512
    ds_read_b64_tr_b16 a[4:5], v36 offset:2048
    ds_read_b64_tr_b16 a[6:7], v36 offset:2560
    ds_read_b64_tr_b16 a[8:9], v36 offset:4096
    ds_read_b64_tr_b16 a[10:11], v36 offset:4608
    ds_read_b64_tr_b16 a[12:13], v36 offset:6144
    ds_read_b64_tr_b16 a[14:15], v36 offset:6656
    ds_read_b64_tr_b16 a[16:17], v36 offset:8192
    ds_read_b64_tr_b16 a[18:19], v36 offset:8704
    ds_read_b64_tr_b16 a[20:21], v36 offset:10240
    ds_read_b64_tr_b16 a[22:23], v36 offset:10752
    ds_read_b64_tr_b16 a[24:25], v36 offset:12288
    ds_read_b64_tr_b16 a[26:27], v36 offset:12800
    ds_read_b64_tr_b16 a[28:29], v36 offset:14336
    ds_read_b64_tr_b16 a[30:31], v36 offset:14848
    ds_read_b64_tr_b16 a[32:33], v36 offset:16384
    ds_read_b64_tr_b16 a[34:35], v36 offset:16896
    v_bfe_i32 v243, v1, 2, 1
    ds_read_b64_tr_b16 a[36:37], v36 offset:18432
    ds_read_b64_tr_b16 a[38:39], v36 offset:18944
    v_and_b32 v243, 0x80008000, v243
    ds_read_b64_tr_b16 a[40:41], v36 offset:20480
    ds_read_b64_tr_b16 a[42:43], v36 offset:20992
    v_add_u32 v245, 157184, v2
    ds_read_b64_tr_b16 a[44:45], v36 offset:22528
    ds_read_b64_tr_b16 a[46:47], v36 offset:23040
    v_add_u32 v246, 23552, v8
    ds_read_b64_tr_b16 a[48:49], v36 offset:24576
    ds_read_b64_tr_b16 a[50:51], v36 offset:25088
    v_add_u32 v247, 47104, v8
    ds_read_b64_tr_b16 a[52:53], v36 offset:26624
    ds_read_b64_tr_b16 a[54:55], v36 offset:27136
    v_add_u32 v248, 70656, v8
    ds_read_b64_tr_b16 a[56:57], v36 offset:28672
    ds_read_b64_tr_b16 a[58:59], v36 offset:29184
    s_branch S_1
T_1:
    s_branch T_5
S_1:
    s_waitcnt lgkmcnt(15)
    v_xor_b32 v48, v48, v243
    ds_read_b64_tr_b16 a[60:61], v36 offset:30720
    ds_read_b64_tr_b16 a[62:63], v36 offset:31232
    v_xor_b32 v49, v49, v243
    ds_read_b64_tr_b16 a[64:65], v36 offset:32768
    ds_read_b64_tr_b16 a[66:67], v36 offset:33280
    v_xor_b32 v50, v50, v243
    ds_read_b64_tr_b16 a[68:69], v36 offset:34816
    ds_read_b64_tr_b16 a[70:71], v36 offset:35328
    v_xor_b32 v51, v51, v243
    ds_read_b64_tr_b16 a[72:73], v36 offset:36864
    ds_read_b64_tr_b16 a[74:75], v36 offset:37376
    v_xor_b32 v52, v52, v243
    ds_read_b64_tr_b16 a[76:77], v36 offset:38912
    ds_read_b64_tr_b16 a[78:79], v36 offset:39424
    v_xor_b32 v53, v53, v243
    ds_read_b64_tr_b16 a[80:81], v36 offset:40960
    ds_read_b64_tr_b16 a[82:83], v36 offset:41472
    v_xor_b32 v54, v54, v243
    ds_read_b64_tr_b16 a[84:85], v36 offset:43008
    ds_read_b64_tr_b16 a[86:87], v36 offset:43520
    v_xor_b32 v55, v55, v243
    ds_read_b64_tr_b16 a[88:89], v36 offset:45056
    ds_read_b64_tr_b16 a[90:91], v36 offset:45568
    v_xor_b32 v56, v56, v243
    ds_read_b64_tr_b16 a[92:93], v36 offset:47104
    ds_read_b64_tr_b16 a[94:95], v36 offset:47616
    v_xor_b32 v57, v57, v243
    ds_read_b64_tr_b16 a[96:97], v36 offset:49152
    ds_read_b64_tr_b16 a[98:99], v36 offset:49664
    v_xor_b32 v58, v58, v243
    ds_read_b64_tr_b16 a[100:101], v36 offset:51200
    ds_read_b64_tr_b16 a[102:103], v36 offset:51712
    v_xor_b32 v59, v59, v243
    ds_read_b64_tr_b16 a[104:105], v36 offset:53248
    ds_read_b64_tr_b16 a[106:107], v36 offset:53760
    ds_read_b64_tr_b16 a[108:109], v36 offset:55296
    ds_read_b64_tr_b16 a[110:111], v36 offset:55808
    ds_read_b64_tr_b16 a[112:113], v36 offset:57344
    ds_read_b64_tr_b16 a[114:115], v36 offset:57856
    ds_read_b64_tr_b16 a[116:117], v36 offset:59392
    ds_read_b64_tr_b16 a[118:119], v36 offset:59904
    ds_read_b64_tr_b16 a[120:121], v36 offset:61440
    ds_read_b64_tr_b16 a[122:123], v36 offset:61952
    ds_read_b64_tr_b16 a[124:125], v36 offset:63488
    ds_read_b64_tr_b16 a[126:127], v36 offset:64000
    s_waitcnt vmcnt(8)
    v_xor_b32 v40, s100, v16
    v_xor_b32 v41, s100, v17
    v_bitop3_b32 v40, v18, s100, v40 bitop3:0xbe
    v_bitop3_b32 v41, v19, s100, v41 bitop3:0xbe
    v_bitop3_b32 v40, v20, s100, v40 bitop3:0xbe
    v_bitop3_b32 v41, v21, s100, v41 bitop3:0xbe
    v_bitop3_b32 v40, v22, s100, v40 bitop3:0xbe
    v_bitop3_b32 v41, v23, s100, v41 bitop3:0xbe
    v_bitop3_b32 v40, v24, s100, v40 bitop3:0xbe
    v_bitop3_b32 v41, v25, s100, v41 bitop3:0xbe
    v_bitop3_b32 v40, v26, s100, v40 bitop3:0xbe
    v_bitop3_b32 v41, v27, s100, v41 bitop3:0xbe
    v_bitop3_b32 v40, v28, s100, v40 bitop3:0xbe
    v_bitop3_b32 v41, v29, s100, v41 bitop3:0xbe
    v_bitop3_b32 v40, v30, s100, v40 bitop3:0xbe
    v_bitop3_b32 v41, v31, s100, v41 bitop3:0xbe
    v_bitop3_b32 v40, v32, s100, v40 bitop3:0xbe
    v_bitop3_b32 v41, v33, s100, v41 bitop3:0xbe
    v_bitop3_b32 v40, v34, s100, v40 bitop3:0xbe
    v_bitop3_b32 v41, v35, s100, v41 bitop3:0xbe
    v_or_b32 v40, v40, v41
    v_and_b32 v40, 63, v40
    v_cmp_ne_u32 vcc, 0, v40
    s_cbranch_vccnz re_1
ok_2:
    s_cmp_ge_u32 s3, 2
    s_cselect_b32 s60, 1.0, 0
    v_pk_add_f32 v[16:17], v[16:17], v[20:21]
    v_pk_add_f32 v[18:19], v[18:19], v[22:23]
    v_pk_add_f32 v[24:25], v[24:25], v[28:29]
    v_pk_add_f32 v[26:27], v[26:27], v[30:31]
    v_pk_add_f32 v[16:17], v[16:17], v[24:25]
    v_pk_add_f32 v[18:19], v[18:19], v[26:27]
    v_cvt_pk_bf16_f32 v20, v16, v17
    v_cvt_pk_bf16_f32 v21, v18, v19
    v_lshlrev_b32 v16, 16, v20
    v_and_b32 v17, 0xffff0000, v20
    v_lshlrev_b32 v18, 16, v21
    v_and_b32 v19, 0xffff0000, v21
    v_add_f32 v16, s60, v16
    v_add_f32 v17, s60, v17
    v_add_f32 v18, s60, v18
    v_add_f32 v19, s60, v19
    v_cvt_pk_bf16_f32 v20, v16, v17
    v_cvt_pk_bf16_f32 v21, v18, v19
    ds_write_b64 v39, v[20:21]
    s_waitcnt lgkmcnt(0)
    s_barrier
    ds_read_b128 v[40:43], v245
    ds_read_b128 v[44:47], v245 offset:1024
    v_add_f32_dpp v32, v32, v32 quad_perm:[2,3,0,1] row_mask:0xf bank_mask:0xf
    s_add_u32 m0, s58, 0
    s_nop 0
    buffer_load_dwordx4 v8, s[40:43], s0 offen offset:0 lds
    v_add_f32_dpp v33, v33, v33 quad_perm:[2,3,0,1] row_mask:0xf bank_mask:0xf
    v_add_f32_dpp v34, v34, v34 quad_perm:[2,3,0,1] row_mask:0xf bank_mask:0xf
    v_add_f32_dpp v35, v35, v35 quad_perm:[2,3,0,1] row_mask:0xf bank_mask:0xf
    v_add_f32_dpp v32, v32, v32 row_ror:4 row_mask:0xf bank_mask:0xf
    v_add_f32_dpp v33, v33, v33 row_ror:4 row_mask:0xf bank_mask:0xf
    v_add_f32_dpp v34, v34, v34 row_ror:4 row_mask:0xf bank_mask:0xf
    v_add_f32_dpp v35, v35, v35 row_ror:4 row_mask:0xf bank_mask:0xf
    s_lshr_b32 s60, s2, 6
    s_cmp_eq_u32 s60, 2
    s_cselect_b32 s62, 1.0, 0
    buffer_load_dwordx4 v246, s[40:43], s0 offen offset:1024 lds
    v_cvt_pk_bf16_f32 v36, v32, v33
    v_cvt_pk_bf16_f32 v37, v34, v35
    v_lshlrev_b32 v32, 16, v36
    v_and_b32 v33, 0xffff0000, v36
    v_lshlrev_b32 v34, 16, v37
    v_and_b32 v35, 0xffff0000, v37
    v_add_f32 v32, s62, v32
    v_add_f32 v33, s62, v33
    v_add_f32 v34, s62, v34
    v_add_f32 v35, s62, v35
    buffer_load_dwordx4 v247, s[40:43], s0 offen offset:2048 lds
    v_cvt_pk_bf16_f32 v36, v32, v33
    v_cvt_pk_bf16_f32 v37, v34, v35
    v_mov_b32 v38, s100
    v_mov_b32 v39, s100
    s_mov_b64 exec, 3
    buffer_store_dwordx4 v[36:39], v2, s[32:35], s53 offen sc1
    s_mov_b64 exec, -1
    s_waitcnt lgkmcnt(0)
    v_lshlrev_b32 v24, 16, v40
    v_and_b32 v25, 0xffff0000, v40
    v_lshlrev_b32 v26, 16, v41
    v_and_b32 v27, 0xffff0000, v41
    v_lshlrev_b32 v28, 16, v42
    v_and_b32 v29, 0xffff0000, v42
    v_lshlrev_b32 v30, 16, v43
    v_and_b32 v31, 0xffff0000, v43
    v_lshlrev_b32 v16, 16, v44
    v_and_b32 v17, 0xffff0000, v44
    buffer_load_dwordx4 v248, s[40:43], s0 offen offset:3072 lds
    v_lshlrev_b32 v18, 16, v45
    v_and_b32 v19, 0xffff0000, v45
    v_lshlrev_b32 v20, 16, v46
    v_and_b32 v21, 0xffff0000, v46
    v_lshlrev_b32 v22, 16, v47
    v_and_b32 v23, 0xffff0000, v47
    v_pk_fma_f32 v[64:65], v[64:65], v[16:17], v[24:25]
    v_pk_fma_f32 v[66:67], v[66:67], v[18:19], v[26:27]
    v_pk_fma_f32 v[68:69], v[68:69], v[20:21], v[28:29]
    v_pk_fma_f32 v[70:71], v[70:71], v[22:23], v[30:31]
    s_add_u32 s0, s0, 98304
    s_add_u32 m0, s58, 4096
    s_nop 0
    buffer_load_dwordx4 v8, s[40:43], s0 offen offset:0 lds
    v_cvt_pk_bf16_f32 v64, v64, v65
    v_cvt_pk_bf16_f32 v65, v66, v67
    v_cvt_pk_bf16_f32 v66, v68, v69
    v_cvt_pk_bf16_f32 v67, v70, v71
    ds_write_b128 v3, v[64:67] offset:0
    buffer_load_dwordx4 v246, s[40:43], s0 offen offset:1024 lds
    v_pk_fma_f32 v[72:73], v[72:73], v[16:17], v[24:25]
    v_pk_fma_f32 v[74:75], v[74:75], v[18:19], v[26:27]
    v_pk_fma_f32 v[76:77], v[76:77], v[20:21], v[28:29]
    v_pk_fma_f32 v[78:79], v[78:79], v[22:23], v[30:31]
    v_cvt_pk_bf16_f32 v72, v72, v73
    v_cvt_pk_bf16_f32 v73, v74, v75
    v_cvt_pk_bf16_f32 v74, v76, v77
    v_cvt_pk_bf16_f32 v75, v78, v79
    ds_write_b128 v3, v[72:75] offset:1040
    buffer_load_dwordx4 v247, s[40:43], s0 offen offset:2048 lds
    v_pk_fma_f32 v[80:81], v[80:81], v[16:17], v[24:25]
    v_pk_fma_f32 v[82:83], v[82:83], v[18:19], v[26:27]
    v_pk_fma_f32 v[84:85], v[84:85], v[20:21], v[28:29]
    v_pk_fma_f32 v[86:87], v[86:87], v[22:23], v[30:31]
    v_cvt_pk_bf16_f32 v80, v80, v81
    v_cvt_pk_bf16_f32 v81, v82, v83
    v_cvt_pk_bf16_f32 v82, v84, v85
    v_cvt_pk_bf16_f32 v83, v86, v87
    ds_write_b128 v3, v[80:83] offset:2080
    buffer_load_dwordx4 v248, s[40:43], s0 offen offset:3072 lds
    v_pk_fma_f32 v[88:89], v[88:89], v[16:17], v[24:25]
    v_pk_fma_f32 v[90:91], v[90:91], v[18:19], v[26:27]
    v_pk_fma_f32 v[92:93], v[92:93], v[20:21], v[28:29]
    v_pk_fma_f32 v[94:95], v[94:95], v[22:23], v[30:31]
    v_cvt_pk_bf16_f32 v88, v88, v89
    v_cvt_pk_bf16_f32 v89, v90, v91
    v_cvt_pk_bf16_f32 v90, v92, v93
    v_cvt_pk_bf16_f32 v91, v94, v95
    ds_write_b128 v3, v[88:91] offset:3120
    s_add_u32 s0, s0, 98304
    s_add_u32 m0, s58, 8192
    s_nop 0
    buffer_load_dwordx4 v8, s[40:43], s0 offen offset:0 lds
    v_pk_fma_f32 v[96:97], v[96:97], v[16:17], v[24:25]
    v_pk_fma_f32 v[98:99], v[98:99], v[18:19], v[26:27]
    v_pk_fma_f32 v[100:101], v[100:101], v[20:21], v[28:29]
    v_pk_fma_f32 v[102:103], v[102:103], v[22:23], v[30:31]
    v_cvt_pk_bf16_f32 v96, v96, v97
    v_cvt_pk_bf16_f32 v97, v98, v99
    v_cvt_pk_bf16_f32 v98, v100, v101
    v_cvt_pk_bf16_f32 v99, v102, v103
    ds_write_b128 v3, v[96:99] offset:4160
    buffer_load_dwordx4 v246, s[40:43], s0 offen offset:1024 lds
    v_pk_fma_f32 v[104:105], v[104:105], v[16:17], v[24:25]
    v_pk_fma_f32 v[106:107], v[106:107], v[18:19], v[26:27]
    v_pk_fma_f32 v[108:109], v[108:109], v[20:21], v[28:29]
    v_pk_fma_f32 v[110:111], v[110:111], v[22:23], v[30:31]
    v_cvt_pk_bf16_f32 v104, v104, v105
    v_cvt_pk_bf16_f32 v105, v106, v107
    v_cvt_pk_bf16_f32 v106, v108, v109
    v_cvt_pk_bf16_f32 v107, v110, v111
    ds_write_b128 v3, v[104:107] offset:5200
    buffer_load_dwordx4 v247, s[40:43], s0 offen offset:2048 lds
    v_pk_fma_f32 v[112:113], v[112:113], v[16:17], v[24:25]
    v_pk_fma_f32 v[114:115], v[114:115], v[18:19], v[26:27]
    v_pk_fma_f32 v[116:117], v[116:117], v[20:21], v[28:29]
    v_pk_fma_f32 v[118:119], v[118:119], v[22:23], v[30:31]
    v_cvt_pk_bf16_f32 v112, v112, v113
    v_cvt_pk_bf16_f32 v113, v114, v115
    v_cvt_pk_bf16_f32 v114, v116, v117
    v_cvt_pk_bf16_f32 v115, v118, v119
    ds_write_b128 v3, v[112:115] offset:6240
    buffer_load_dwordx4 v248, s[40:43], s0 offen offset:3072 lds
    v_pk_fma_f32 v[120:121], v[120:121], v[16:17], v[24:25]
    v_pk_fma_f32 v[122:123], v[122:123], v[18:19], v[26:27]
    v_pk_fma_f32 v[124:125], v[124:125], v[20:21], v[28:29]
    v_pk_fma_f32 v[126:127], v[126:127], v[22:23], v[30:31]
    v_cvt_pk_bf16_f32 v120, v120, v121
    v_cvt_pk_bf16_f32 v121, v122, v123
    v_cvt_pk_bf16_f32 v122, v124, v125
    v_cvt_pk_bf16_f32 v123, v126, v127
    ds_write_b128 v3, v[120:123] offset:7280
    s_add_u32 s0, s0, 98304
    s_add_u32 m0, s58, 12288
    s_nop 0
    buffer_load_dwordx4 v8, s[40:43], s0 offen offset:0 lds
    v_mov_b32 v76, 0x3f803f80
    v_mov_b32 v77, 0x3f803f80
    v_mov_b32 v78, 0x3f803f80
    v_mov_b32 v79, 0x3f803f80
    s_waitcnt vmcnt(14)
    s_waitcnt lgkmcnt(0)
    s_barrier
    ds_read_b64_tr_b16 a[232:233], v60 offset:0
    ds_read_b64_tr_b16 a[234:235], v61 offset:0
    buffer_load_dwordx4 v246, s[40:43], s0 offen offset:1024 lds
    ds_read_b64_tr_b16 a[236:237], v60 offset:128
    ds_read_b64_tr_b16 a[238:239], v61 offset:128
    ds_read_b64_tr_b16 a[240:241], v60 offset:256
    ds_read_b64_tr_b16 a[242:243], v61 offset:256
    ds_read_b64_tr_b16 a[244:245], v60 offset:384
    ds_read_b64_tr_b16 a[246:247], v61 offset:384
    ds_read_b64_tr_b16 a[248:249], v60 offset:512
    buffer_load_dwordx4 v247, s[40:43], s0 offen offset:2048 lds
    ds_read_b64_tr_b16 a[250:251], v61 offset:512
    ds_read_b64_tr_b16 a[252:253], v60 offset:640
    ds_read_b64_tr_b16 a[254:255], v61 offset:640
    ds_read_b128 v[224:227], v4 offset:0
    ds_read_b128 v[228:231], v4 offset:32
    ds_read_b128 v[232:235], v4 offset:64
    s_waitcnt lgkmcnt(2)
    v_mfma_f32_32x32x16_bf16 v[192:207], a[0:3], v[224:227], 0
    buffer_store_dwordx4 a[232:235], v2, s[32:35], s55 offen sc1
    s_add_u32 s55, s55, s56
    ds_read_b128 v[236:239], v4 offset:96
    s_mul_i32 s60, s89, 47
    s_mul_i32 s61, s90, 47
    v_mov_b32 v12, s61
    v_mov_b32 v40, s60
    s_waitcnt lgkmcnt(2)
    v_mfma_f32_32x32x16_bf16 v[192:207], a[4:7], v[228:231], v[192:207]
    ds_read_b128 v[224:227], v4 offset:128
    v_cmp_gt_u32 vcc, 16, v1
    s_lshr_b32 s61, s85, 3
    s_nop 0
    v_cndmask_b32 v12, v12, v40, vcc
    s_add_u32 s61, s61, 4
    s_waitcnt lgkmcnt(2)
    v_mfma_f32_32x32x16_bf16 v[192:207], a[8:11], v[232:235], v[192:207]
    ds_read_b128 v[228:231], v4 offset:160
    v_lshrrev_b32 v12, 10, v12
    v_and_b32 v40, 15, v1
    v_lshl_add_u32 v12, v12, 4, v40
    v_and_b32 v40, 7, v1
    s_waitcnt lgkmcnt(2)
    v_mfma_f32_32x32x16_bf16 v[192:207], a[12:15], v[236:239], v[192:207]
    buffer_store_dwordx4 a[236:239], v2, s[32:35], s55 offen sc1
    s_add_u32 s55, s55, s56
    ds_read_b128 v[232:235], v4 offset:192
    v_lshl_add_u32 v40, s61, 4, v40
    v_cmp_gt_u32 vcc, 32, v1
    s_mov_b32 s60, 393216
    s_nop 0
    v_cndmask_b32 v12, v40, v12, vcc
    s_waitcnt lgkmcnt(2)
    v_mfma_f32_32x32x16_bf16 v[192:207], a[16:19], v[224:227], v[192:207]
    ds_read_b128 v[236:239], v4 offset:224
    v_lshl_add_u32 v90, v12, 5, s60
    v_mov_b32 v80, -1
    v_mov_b32 v81, -1
    v_mov_b32 v82, -1
    s_waitcnt lgkmcnt(2)
    v_mfma_f32_32x32x16_bf16 v[192:207], a[20:23], v[228:231], v[192:207]
    ds_read_b128 v[224:227], v4 offset:256
    v_mov_b32 v83, -1
    v_fma_f32 v128, v128, v16, v24
    v_fma_f32 v129, v129, v17, v25
    v_fma_f32 v130, v130, v18, v26
    s_waitcnt lgkmcnt(2)
    v_mfma_f32_32x32x16_bf16 v[192:207], a[24:27], v[232:235], v[192:207]
    buffer_store_dwordx4 a[240:243], v2, s[32:35], s55 offen sc1
    s_add_u32 s55, s55, s56
    ds_read_b128 v[228:231], v4 offset:288
    v_fma_f32 v131, v131, v19, v27
    v_fma_f32 v132, v132, v20, v28
    v_fma_f32 v133, v133, v21, v29
    v_fma_f32 v134, v134, v22, v30
    s_waitcnt lgkmcnt(2)
    v_mfma_f32_32x32x16_bf16 v[192:207], a[28:31], v[236:239], v[192:207]
    ds_read_b128 v[232:235], v4 offset:320
    v_fma_f32 v135, v135, v23, v31
    v_cvt_pk_bf16_f32 v128, v128, v129
    v_cvt_pk_bf16_f32 v129, v130, v131
    v_cvt_pk_bf16_f32 v130, v132, v133
    s_waitcnt lgkmcnt(2)
    v_mfma_f32_32x32x16_bf16 v[192:207], a[32:35], v[224:227], v[192:207]
    ds_read_b128 v[236:239], v4 offset:352
    v_cvt_pk_bf16_f32 v131, v134, v135
    ds_write_b128 v3, v[128:131] offset:33280
    buffer_store_dwordx4 a[244:247], v2, s[32:35], s55 offen sc1
    s_add_u32 s55, s55, s56
    v_fma_f32 v136, v136, v16, v24
    v_fma_f32 v137, v137, v17, v25
    s_waitcnt lgkmcnt(3)
    v_mfma_f32_32x32x16_bf16 v[192:207], a[36:39], v[228:231], v[192:207]
    ds_read_b128 v[224:227], v4 offset:384
    v_fma_f32 v138, v138, v18, v26
    v_fma_f32 v139, v139, v19, v27
    v_fma_f32 v140, v140, v20, v28
    v_fma_f32 v141, v141, v21, v29
    s_waitcnt lgkmcnt(3)
    v_mfma_f32_32x32x16_bf16 v[192:207], a[40:43], v[232:235], v[192:207]
    ds_read_b128 v[228:231], v4 offset:416
    v_fma_f32 v142, v142, v22, v30
    v_fma_f32 v143, v143, v23, v31
    v_cvt_pk_bf16_f32 v136, v136, v137
    v_cvt_pk_bf16_f32 v137, v138, v139
    s_waitcnt lgkmcnt(3)
    v_mfma_f32_32x32x16_bf16 v[192:207], a[44:47], v[236:239], v[192:207]
    ds_read_b128 v[232:235], v4 offset:448
    v_cvt_pk_bf16_f32 v138, v140, v141
    v_cvt_pk_bf16_f32 v139, v142, v143
    ds_write_b128 v3, v[136:139] offset:34320
    s_cmp_gt_u32 s57, 4
    s_cselect_b32 s55, s55, 0x8000000
    buffer_store_dwordx4 a[248:251], v2, s[32:35], s55 offen sc1
    s_add_u32 s55, s55, s56
    v_fma_f32 v144, v144, v16, v24
    s_waitcnt lgkmcnt(3)
    v_mfma_f32_32x32x16_bf16 v[192:207], a[48:51], v[224:227], v[192:207]
    ds_read_b128 v[236:239], v4 offset:480
    v_fma_f32 v145, v145, v17, v25
    v_fma_f32 v146, v146, v18, v26
    v_fma_f32 v147, v147, v19, v27
    v_fma_f32 v148, v148, v20, v28
    s_waitcnt lgkmcnt(3)
    v_mfma_f32_32x32x16_bf16 v[192:207], a[52:55], v[228:231], v[192:207]
    ds_read_b128 v[224:227], v4 offset:512
    v_fma_f32 v149, v149, v21, v29
    v_fma_f32 v150, v150, v22, v30
    v_fma_f32 v151, v151, v23, v31
    v_cvt_pk_bf16_f32 v144, v144, v145
    s_waitcnt lgkmcnt(3)
    v_mfma_f32_32x32x16_bf16 v[192:207], a[56:59], v[232:235], v[192:207]
    ds_read_b128 v[228:231], v4 offset:544
    v_cvt_pk_bf16_f32 v145, v146, v147
    v_cvt_pk_bf16_f32 v146, v148, v149
    v_cvt_pk_bf16_f32 v147, v150, v151
    ds_write_b128 v3, v[144:147] offset:35360
    s_cmp_gt_u32 s57, 5
    s_cselect_b32 s55, s55, 0x8000000
    buffer_store_dwordx4 a[252:255], v2, s[32:35], s55 offen sc1
    s_waitcnt lgkmcnt(3)
    v_mfma_f32_32x32x16_bf16 v[192:207], a[60:63], v[236:239], v[192:207]
    ds_read_b128 v[232:235], v4 offset:576
    v_fma_f32 v152, v152, v16, v24
    v_fma_f32 v153, v153, v17, v25
    v_fma_f32 v154, v154, v18, v26
    v_fma_f32 v155, v155, v19, v27
    s_waitcnt lgkmcnt(3)
    v_mfma_f32_32x32x16_bf16 v[192:207], a[64:67], v[224:227], v[192:207]
    ds_read_b128 v[236:239], v4 offset:608
    v_fma_f32 v156, v156, v20, v28
    v_fma_f32 v157, v157, v21, v29
    v_fma_f32 v158, v158, v22, v30
    v_fma_f32 v159, v159, v23, v31
    s_waitcnt lgkmcnt(3)
    v_mfma_f32_32x32x16_bf16 v[192:207], a[68:71], v[228:231], v[192:207]
    ds_read_b128 v[224:227], v4 offset:640
    v_cvt_pk_bf16_f32 v152, v152, v153
    v_cvt_pk_bf16_f32 v153, v154, v155
    v_cvt_pk_bf16_f32 v154, v156, v157
    v_cvt_pk_bf16_f32 v155, v158, v159
    s_waitcnt lgkmcnt(2)
    v_mfma_f32_32x32x16_bf16 v[192:207], a[72:75], v[232:235], v[192:207]
    buffer_load_dwordx4 v248, s[40:43], s0 offen offset:3072 lds
    ds_read_b128 v[228:231], v4 offset:672
    ds_write_b128 v3, v[152:155] offset:36400
    v_fma_f32 v160, v160, v16, v24
    v_fma_f32 v161, v161, v17, v25
    v_fma_f32 v162, v162, v18, v26
    s_waitcnt lgkmcnt(3)
    v_mfma_f32_32x32x16_bf16 v[192:207], a[76:79], v[236:239], v[192:207]
    ds_read_b128 v[232:235], v4 offset:704
    v_fma_f32 v163, v163, v19, v27
    v_fma_f32 v164, v164, v20, v28
    v_fma_f32 v165, v165, v21, v29
    v_fma_f32 v166, v166, v22, v30
    s_waitcnt lgkmcnt(3)
    v_mfma_f32_32x32x16_bf16 v[192:207], a[80:83], v[224:227], v[192:207]
    ds_read_b128 v[236:239], v4 offset:736
    v_fma_f32 v167, v167, v23, v31
    v_cvt_pk_bf16_f32 v160, v160, v161
    v_cvt_pk_bf16_f32 v161, v162, v163
    v_cvt_pk_bf16_f32 v162, v164, v165
    s_waitcnt lgkmcnt(3)
    v_mfma_f32_32x32x16_bf16 v[192:207], a[84:87], v[228:231], v[192:207]
    ds_read_b128 v[224:227], v4 offset:768
    v_cvt_pk_bf16_f32 v163, v166, v167
    ds_write_b128 v3, v[160:163] offset:37440
    v_fma_f32 v168, v168, v16, v24
    v_fma_f32 v169, v169, v17, v25
    s_waitcnt lgkmcnt(3)
    v_mfma_f32_32x32x16_bf16 v[192:207], a[88:91], v[232:235], v[192:207]
    ds_read_b128 v[228:231], v4 offset:800
    v_fma_f32 v170, v170, v18, v26
    v_fma_f32 v171, v171, v19, v27
    v_fma_f32 v172, v172, v20, v28
    v_fma_f32 v173, v173, v21, v29
    s_waitcnt lgkmcnt(3)
    v_mfma_f32_32x32x16_bf16 v[192:207], a[92:95], v[236:239], v[192:207]
    ds_read_b128 v[232:235], v4 offset:832
    v_fma_f32 v174, v174, v22, v30
    v_fma_f32 v175, v175, v23, v31
    v_cvt_pk_bf16_f32 v168, v168, v169
    v_cvt_pk_bf16_f32 v169, v170, v171
    s_waitcnt lgkmcnt(3)
    v_mfma_f32_32x32x16_bf16 v[192:207], a[96:99], v[224:227], v[192:207]
    ds_read_b128 v[236:239], v4 offset:864
    v_cvt_pk_bf16_f32 v170, v172, v173
    v_cvt_pk_bf16_f32 v171, v174, v175
    ds_write_b128 v3, v[168:171] offset:38480
    v_fma_f32 v176, v176, v16, v24
    s_waitcnt lgkmcnt(3)
    v_mfma_f32_32x32x16_bf16 v[192:207], a[100:103], v[228:231], v[192:207]
    ds_read_b128 v[224:227], v4 offset:896
    v_fma_f32 v177, v177, v17, v25
    v_fma_f32 v178, v178, v18, v26
    v_fma_f32 v179, v179, v19, v27
    v_fma_f32 v180, v180, v20, v28
    s_waitcnt lgkmcnt(3)
    v_mfma_f32_32x32x16_bf16 v[192:207], a[104:107], v[232:235], v[192:207]
    ds_read_b128 v[228:231], v4 offset:928
    v_fma_f32 v181, v181, v21, v29
    v_fma_f32 v182, v182, v22, v30
    v_fma_f32 v183, v183, v23, v31
    v_cvt_pk_bf16_f32 v176, v176, v177
    s_waitcnt lgkmcnt(3)
    v_mfma_f32_32x32x16_bf16 v[192:207], a[108:111], v[236:239], v[192:207]
    ds_read_b128 v[232:235], v4 offset:960
    v_cvt_pk_bf16_f32 v177, v178, v179
    v_cvt_pk_bf16_f32 v178, v180, v181
    v_cvt_pk_bf16_f32 v179, v182, v183
    ds_write_b128 v3, v[176:179] offset:39520
    s_waitcnt lgkmcnt(3)
    v_mfma_f32_32x32x16_bf16 v[192:207], a[112:115], v[224:227], v[192:207]
    ds_read_b128 v[236:239], v4 offset:992
    v_fma_f32 v184, v184, v16, v24
    v_fma_f32 v185, v185, v17, v25
    v_fma_f32 v186, v186, v18, v26
    v_fma_f32 v187, v187, v19, v27
    s_waitcnt lgkmcnt(3)
    v_mfma_f32_32x32x16_bf16 v[192:207], a[116:119], v[228:231], v[192:207]
    v_fma_f32 v188, v188, v20, v28
    v_fma_f32 v189, v189, v21, v29
    v_fma_f32 v190, v190, v22, v30
    v_fma_f32 v191, v191, v23, v31
    s_waitcnt lgkmcnt(2)
    v_mfma_f32_32x32x16_bf16 v[192:207], a[120:123], v[232:235], v[192:207]
    v_cvt_pk_bf16_f32 v184, v184, v185
    v_cvt_pk_bf16_f32 v185, v186, v187
    v_cvt_pk_bf16_f32 v186, v188, v189
    v_cvt_pk_bf16_f32 v187, v190, v191
    s_waitcnt lgkmcnt(0)
    v_mfma_f32_32x32x16_bf16 v[192:207], a[124:127], v[236:239], v[192:207]
    ds_write_b128 v3, v[184:187] offset:40560
    s_waitcnt vmcnt(1)
    s_waitcnt lgkmcnt(0)
    s_barrier
    s_mov_b64 exec, 1
    buffer_store_dword v62, v2, s[32:35], s54 offen sc1
    s_mov_b64 exec, -1
    ds_read_b128 v[224:227], v4 offset:33280
    ds_read_b128 v[228:231], v4 offset:33312
    ds_read_b128 v[232:235], v4 offset:33344
    s_waitcnt lgkmcnt(2)
    v_mfma_f32_32x32x16_bf16 v[208:223], a[0:3], v[224:227], 0
    ds_read_b128 v[236:239], v4 offset:33376
    v_cvt_pk_bf16_f32 v192, v192, v193
    buffer_store_dwordx4 v[80:83], v2, s[32:35], s83 offen offset:0 sc1
    v_cvt_pk_bf16_f32 v193, v194, v195
    v_cvt_pk_bf16_f32 v194, v196, v197
    v_cvt_pk_bf16_f32 v195, v198, v199
    s_waitcnt lgkmcnt(2)
    v_mfma_f32_32x32x16_bf16 v[208:223], a[4:7], v[228:231], v[208:223]
    ds_read_b128 v[224:227], v4 offset:33408
    v_mfma_f32_32x32x16_bf16 v[240:255], v[48:51], v[192:195], 0
    v_cvt_pk_bf16_f32 v200, v200, v201
    v_cvt_pk_bf16_f32 v201, v202, v203
    s_waitcnt lgkmcnt(2)
    v_mfma_f32_32x32x16_bf16 v[208:223], a[8:11], v[232:235], v[208:223]
    ds_read_b128 v[228:231], v4 offset:33440
    v_cvt_pk_bf16_f32 v202, v204, v205
    v_cvt_pk_bf16_f32 v203, v206, v207
    ds_write_b128 v11, v[200:203] offset:64
    buffer_store_dwordx4 v[80:83], v2, s[32:35], s83 offen offset:1024 sc1
    s_waitcnt lgkmcnt(3)
    v_mfma_f32_32x32x16_bf16 v[208:223], a[12:15], v[236:239], v[208:223]
    ds_read_b128 v[232:235], v4 offset:33472
    v_max3_f32 v60, v240, v241, v242
    v_max3_f32 v61, v243, v244, v245
    v_max3_f32 v60, v60, v246, v247
    v_max3_f32 v61, v61, v248, v249
    s_waitcnt lgkmcnt(3)
    v_mfma_f32_32x32x16_bf16 v[208:223], a[16:19], v[224:227], v[208:223]
    ds_read_b128 v[236:239], v4 offset:33504
    v_max3_f32 v60, v60, v250, v251
    v_max3_f32 v61, v61, v252, v253
    v_max3_f32 v60, v60, v254, v255
    v_max_f32 v60, v60, v61
    s_waitcnt lgkmcnt(3)
    v_mfma_f32_32x32x16_bf16 v[208:223], a[20:23], v[228:231], v[208:223]
    ds_read_b128 v[224:227], v4 offset:33536
    v_mul_f32 v60, 0xbfb8aa3b, v60
    v_fma_f32 v240, v240, s46, v60
    v_fma_f32 v241, v241, s46, v60
    v_exp_f32 v240, v240
    s_waitcnt lgkmcnt(2)
    v_mfma_f32_32x32x16_bf16 v[208:223], a[24:27], v[232:235], v[208:223]
    buffer_store_dwordx4 v[80:83], v2, s[32:35], s10 offen offset:0 sc1
    ds_read_b128 v[228:231], v4 offset:33568
    v_fma_f32 v242, v242, s46, v60
    v_exp_f32 v241, v241
    v_fma_f32 v243, v243, s46, v60
    s_waitcnt lgkmcnt(2)
    v_mfma_f32_32x32x16_bf16 v[208:223], a[28:31], v[236:239], v[208:223]
    ds_read_b128 v[232:235], v4 offset:33600
    v_exp_f32 v242, v242
    v_fma_f32 v244, v244, s46, v60
    v_exp_f32 v243, v243
    s_waitcnt lgkmcnt(2)
    v_mfma_f32_32x32x16_bf16 v[208:223], a[32:35], v[224:227], v[208:223]
    ds_read_b128 v[236:239], v4 offset:33632
    v_add_f32 v61, v240, v241
    v_fma_f32 v245, v245, s46, v60
    v_exp_f32 v244, v244
    s_waitcnt lgkmcnt(2)
    v_mfma_f32_32x32x16_bf16 v[208:223], a[36:39], v[228:231], v[208:223]
    ds_read_b128 v[224:227], v4 offset:33664
    buffer_store_dwordx4 v[80:83], v2, s[32:35], s10 offen offset:1024 sc1
    v_add_f32 v61, v61, v242
    v_fma_f32 v246, v246, s46, v60
    v_exp_f32 v245, v245
    s_waitcnt lgkmcnt(2)
    v_mfma_f32_32x32x16_bf16 v[208:223], a[40:43], v[232:235], v[208:223]
    ds_read_b128 v[228:231], v4 offset:33696
    v_add_f32 v61, v61, v243
    v_fma_f32 v247, v247, s46, v60
    v_exp_f32 v246, v246
    s_waitcnt lgkmcnt(2)
    v_mfma_f32_32x32x16_bf16 v[208:223], a[44:47], v[236:239], v[208:223]
    s_branch S_2
T_2:
    s_branch T_6
S_2:
    ds_read_b128 v[232:235], v4 offset:33728
    v_add_f32 v61, v61, v244
    v_fma_f32 v248, v248, s46, v60
    v_exp_f32 v247, v247
    s_waitcnt lgkmcnt(2)
    v_mfma_f32_32x32x16_bf16 v[208:223], a[48:51], v[224:227], v[208:223]
    ds_read_b128 v[236:239], v4 offset:33760
    v_add_f32 v61, v61, v245
    v_fma_f32 v249, v249, s46, v60
    buffer_store_dwordx4 v[80:83], v2, s[32:35], s10 offen offset:2048 sc1
    v_exp_f32 v248, v248
    s_waitcnt lgkmcnt(2)
    v_mfma_f32_32x32x16_bf16 v[208:223], a[52:55], v[228:231], v[208:223]
    ds_read_b128 v[224:227], v4 offset:33792
    v_add_f32 v61, v61, v246
    v_fma_f32 v250, v250, s46, v60
    v_exp_f32 v249, v249
    s_waitcnt lgkmcnt(2)
    v_mfma_f32_32x32x16_bf16 v[208:223], a[56:59], v[232:235], v[208:223]
    ds_read_b128 v[228:231], v4 offset:33824
    v_add_f32 v61, v61, v247
    v_fma_f32 v251, v251, s46, v60
    v_exp_f32 v250, v250
    s_waitcnt lgkmcnt(2)
    v_mfma_f32_32x32x16_bf16 v[208:223], a[60:63], v[236:239], v[208:223]
    ds_read_b128 v[232:235], v4 offset:33856
    v_add_f32 v61, v61, v248
    v_fma_f32 v252, v252, s46, v60
    v_exp_f32 v251, v251
    buffer_store_dwordx4 v[80:83], v2, s[32:35], s11 offen offset:0 sc1
    s_waitcnt lgkmcnt(2)
    v_mfma_f32_32x32x16_bf16 v[208:223], a[64:67], v[224:227], v[208:223]
    ds_read_b128 v[236:239], v4 offset:33888
    v_add_f32 v61, v61, v249
    v_fma_f32 v253, v253, s46, v60
    v_exp_f32 v252, v252
    s_waitcnt lgkmcnt(2)
    v_mfma_f32_32x32x16_bf16 v[208:223], a[68:71], v[228:231], v[208:223]
    ds_read_b128 v[224:227], v4 offset:33920
    v_add_f32 v61, v61, v250
    v_fma_f32 v254, v254, s46, v60
    v_exp_f32 v253, v253
    s_waitcnt lgkmcnt(2)
    v_mfma_f32_32x32x16_bf16 v[208:223], a[72:75], v[232:235], v[208:223]
    ds_read_b128 v[228:231], v4 offset:33952
    v_add_f32 v61, v61, v251
    v_fma_f32 v255, v255, s46, v60
    v_exp_f32 v254, v254
    s_waitcnt lgkmcnt(2)
    v_mfma_f32_32x32x16_bf16 v[208:223], a[76:79], v[236:239], v[208:223]
    buffer_store_dwordx4 v[80:83], v2, s[32:35], s11 offen offset:1024 sc1
    ds_read_b128 v[232:235], v4 offset:33984
    v_add_f32 v61, v61, v252
    v_exp_f32 v255, v255
    v_add_f32 v61, v61, v253
    s_waitcnt lgkmcnt(2)
    v_mfma_f32_32x32x16_bf16 v[208:223], a[80:83], v[224:227], v[208:223]
    ds_read_b128 v[236:239], v4 offset:34016
    v_add_f32 v61, v61, v254
    v_add_f32 v61, v61, v255
    v_rcp_f32 v60, v61
    s_waitcnt lgkmcnt(2)
    v_mfma_f32_32x32x16_bf16 v[208:223], a[84:87], v[228:231], v[208:223]
    ds_read_b128 v[224:227], v4 offset:34048
    v_mul_f32 v240, v240, v60
    v_mul_f32 v241, v241, v60
    v_mul_f32 v242, v242, v60
    v_mul_f32 v243, v243, v60
    s_waitcnt lgkmcnt(2)
    v_mfma_f32_32x32x16_bf16 v[208:223], a[88:91], v[232:235], v[208:223]
    ds_read_b128 v[228:231], v4 offset:34080
    buffer_store_dwordx4 v[80:83], v2, s[32:35], s11 offen offset:2048 sc1
    v_mul_f32 v244, v244, v60
    v_mul_f32 v245, v245, v60
    v_mul_f32 v246, v246, v60
    v_mul_f32 v247, v247, v60
    s_waitcnt lgkmcnt(2)
    v_mfma_f32_32x32x16_bf16 v[208:223], a[92:95], v[236:239], v[208:223]
    ds_read_b128 v[232:235], v4 offset:34112
    v_mul_f32 v248, v248, v60
    v_mul_f32 v249, v249, v60
    v_mul_f32 v250, v250, v60
    v_mul_f32 v251, v251, v60
    s_waitcnt lgkmcnt(2)
    v_mfma_f32_32x32x16_bf16 v[208:223], a[96:99], v[224:227], v[208:223]
    ds_read_b128 v[236:239], v4 offset:34144
    v_mul_f32 v252, v252, v60
    v_mul_f32 v253, v253, v60
    v_mul_f32 v254, v254, v60
    v_mul_f32 v255, v255, v60
    s_waitcnt lgkmcnt(2)
    v_mfma_f32_32x32x16_bf16 v[208:223], a[100:103], v[228:231], v[208:223]
    ds_read_b128 v[224:227], v4 offset:34176
    v_cvt_pk_bf16_f32 v240, v240, v241
    v_cvt_pk_bf16_f32 v241, v242, v243
    v_cvt_pk_bf16_f32 v242, v244, v245
    v_cvt_pk_bf16_f32 v243, v246, v247
    s_waitcnt lgkmcnt(2)
    v_mfma_f32_32x32x16_bf16 v[208:223], a[104:107], v[232:235], v[208:223]
    ds_read_b128 v[228:231], v4 offset:34208
    v_cvt_pk_bf16_f32 v244, v248, v249
    v_cvt_pk_bf16_f32 v245, v250, v251
    v_cvt_pk_bf16_f32 v246, v252, v253
    v_cvt_pk_bf16_f32 v247, v254, v255
    s_waitcnt lgkmcnt(2)
    v_mfma_f32_32x32x16_bf16 v[208:223], a[108:111], v[236:239], v[208:223]
    ds_read_b128 v[232:235], v4 offset:34240
    ds_write_b128 v5, v[240:243] offset:0
    ds_write_b128 v5, v[244:247] offset:16
    ds_read_b64_tr_b16 v[72:73], v10 offset:64
    ds_read_b64_tr_b16 v[74:75], v10 offset:512
    s_waitcnt lgkmcnt(6)
    v_mfma_f32_32x32x16_bf16 v[208:223], a[112:115], v[224:227], v[208:223]
    ds_read_b128 v[236:239], v4 offset:34272
    ds_read_b64_tr_b16 v[64:65], v6 offset:0
    ds_read_b64_tr_b16 v[66:67], v6 offset:448
    ds_read_b64_tr_b16 v[68:69], v6 offset:8
    ds_read_b64_tr_b16 v[70:71], v6 offset:456
    s_waitcnt lgkmcnt(10)
    v_mfma_f32_32x32x16_bf16 v[208:223], a[116:119], v[228:231], v[208:223]
    s_waitcnt lgkmcnt(2)
    v_mfma_f32_16x16x32_bf16 v[32:35], v[64:67], v[72:75], 0
    v_mfma_f32_16x16x32_bf16 v[40:43], v[64:67], v[76:79], 0
    v_mfma_f32_32x32x16_bf16 v[208:223], a[120:123], v[232:235], v[208:223]
    s_waitcnt lgkmcnt(0)
    v_mfma_f32_16x16x32_bf16 v[36:39], v[68:71], v[72:75], 0
    v_mfma_f32_16x16x32_bf16 v[44:47], v[68:71], v[76:79], 0
    v_mfma_f32_32x32x16_bf16 v[208:223], a[124:127], v[236:239], v[208:223]
    s_nop 11
    v_cvt_pk_bf16_f32 v208, v208, v209
    v_cvt_pk_bf16_f32 v209, v210, v211
    v_cvt_pk_bf16_f32 v210, v212, v213
    v_cvt_pk_bf16_f32 v211, v214, v215
    s_nop 1
    v_mfma_f32_32x32x16_bf16 v[240:255], v[48:51], v[208:211], 0
    v_cvt_pk_bf16_f32 v216, v216, v217
    v_cvt_pk_bf16_f32 v217, v218, v219
    v_cvt_pk_bf16_f32 v218, v220, v221
    v_cvt_pk_bf16_f32 v219, v222, v223
    ds_write_b128 v11, v[216:219] offset:3648
    s_nop 6
    v_max3_f32 v60, v240, v241, v242
    v_max3_f32 v61, v243, v244, v245
    v_max3_f32 v60, v60, v246, v247
    v_max3_f32 v61, v61, v248, v249
    v_max3_f32 v60, v60, v250, v251
    v_max3_f32 v61, v61, v252, v253
    v_max3_f32 v60, v60, v254, v255
    v_max_f32 v60, v60, v61
    v_mul_f32 v60, 0xbfb8aa3b, v60
    v_pk_fma_f32 v[240:241], v[240:241], s[46:47], v[60:61] op_sel_hi:[1,0,0]
    v_pk_fma_f32 v[242:243], v[242:243], s[46:47], v[60:61] op_sel_hi:[1,0,0]
    v_pk_fma_f32 v[244:245], v[244:245], s[46:47], v[60:61] op_sel_hi:[1,0,0]
    v_pk_fma_f32 v[246:247], v[246:247], s[46:47], v[60:61] op_sel_hi:[1,0,0]
    v_pk_fma_f32 v[248:249], v[248:249], s[46:47], v[60:61] op_sel_hi:[1,0,0]
    v_pk_fma_f32 v[250:251], v[250:251], s[46:47], v[60:61] op_sel_hi:[1,0,0]
    v_pk_fma_f32 v[252:253], v[252:253], s[46:47], v[60:61] op_sel_hi:[1,0,0]
    v_pk_fma_f32 v[254:255], v[254:255], s[46:47], v[60:61] op_sel_hi:[1,0,0]
    v_exp_f32 v240, v240
    v_exp_f32 v241, v241
    v_exp_f32 v242, v242
    v_exp_f32 v243, v243
    v_exp_f32 v244, v244
    v_exp_f32 v245, v245
    v_exp_f32 v246, v246
    v_exp_f32 v247, v247
    v_exp_f32 v248, v248
    v_exp_f32 v249, v249
    v_exp_f32 v250, v250
    v_exp_f32 v251, v251
    v_exp_f32 v252, v252
    v_exp_f32 v253, v253
    v_exp_f32 v254, v254
    v_exp_f32 v255, v255
    v_pk_add_f32 v[60:61], v[240:241], v[242:243]
    v_pk_add_f32 v[62:63], v[244:245], v[246:247]
    v_pk_add_f32 v[60:61], v[60:61], v[248:249]
    v_pk_add_f32 v[62:63], v[62:63], v[250:251]
    v_pk_add_f32 v[60:61], v[60:61], v[252:253]
    v_pk_add_f32 v[62:63], v[62:63], v[254:255]
    v_pk_add_f32 v[60:61], v[60:61], v[62:63]
    v_add_f32 v60, v60, v61
    v_rcp_f32 v60, v60
    s_nop 0
    v_pk_mul_f32 v[240:241], v[240:241], v[60:61] op_sel_hi:[1,0]
    v_pk_mul_f32 v[242:243], v[242:243], v[60:61] op_sel_hi:[1,0]
    v_pk_mul_f32 v[244:245], v[244:245], v[60:61] op_sel_hi:[1,0]
    v_pk_mul_f32 v[246:247], v[246:247], v[60:61] op_sel_hi:[1,0]
    v_pk_mul_f32 v[248:249], v[248:249], v[60:61] op_sel_hi:[1,0]
    v_pk_mul_f32 v[250:251], v[250:251], v[60:61] op_sel_hi:[1,0]
    v_pk_mul_f32 v[252:253], v[252:253], v[60:61] op_sel_hi:[1,0]
    v_pk_mul_f32 v[254:255], v[254:255], v[60:61] op_sel_hi:[1,0]
    v_cvt_pk_bf16_f32 v240, v240, v241
    v_cvt_pk_bf16_f32 v241, v242, v243
    v_cvt_pk_bf16_f32 v242, v244, v245
    v_cvt_pk_bf16_f32 v243, v246, v247
    v_cvt_pk_bf16_f32 v244, v248, v249
    v_cvt_pk_bf16_f32 v245, v250, v251
    v_cvt_pk_bf16_f32 v246, v252, v253
    v_cvt_pk_bf16_f32 v247, v254, v255
    ds_write_b128 v5, v[240:243] offset:3584
    ds_write_b128 v5, v[244:247] offset:3600
    ds_read_b64_tr_b16 v[72:73], v10 offset:3648
    ds_read_b64_tr_b16 v[74:75], v10 offset:4096
    ds_read_b64_tr_b16 v[64:65], v6 offset:3584
    ds_read_b64_tr_b16 v[66:67], v6 offset:4032
    ds_read_b64_tr_b16 v[68:69], v6 offset:3592
    ds_read_b64_tr_b16 v[70:71], v6 offset:4040
    s_waitcnt lgkmcnt(2)
    v_mfma_f32_16x16x32_bf16 v[32:35], v[64:67], v[72:75], v[32:35]
    v_mfma_f32_16x16x32_bf16 v[40:43], v[64:67], v[76:79], v[40:43]
    s_waitcnt lgkmcnt(0)
    v_mfma_f32_16x16x32_bf16 v[36:39], v[68:71], v[72:75], v[36:39]
    v_mfma_f32_16x16x32_bf16 v[44:47], v[68:71], v[76:79], v[44:47]
    s_mov_b32 vcc_lo, 0xaaaaaaaa
    s_mov_b32 vcc_hi, 0xaaaaaaaa
    s_nop 1
    v_bfi_b32 v32, 63, s100, v32
    v_bfi_b32 v33, 63, s100, v33
    v_bfi_b32 v34, 63, s100, v34
    v_bfi_b32 v35, 63, s100, v35
    buffer_store_dwordx4 v[32:35], v13, s[32:35], s18 offen sc1
    v_bfi_b32 v36, 63, s100, v36
    v_bfi_b32 v37, 63, s100, v37
    v_bfi_b32 v38, 63, s100, v38
    v_bfi_b32 v39, 63, s100, v39
    buffer_store_dwordx4 v[36:39], v13, s[32:35], s18 offen offset:128 sc1
    v_cndmask_b32 v40, v40, v44, vcc
    v_cndmask_b32 v41, v41, v45, vcc
    v_cndmask_b32 v42, v42, v46, vcc
    v_cndmask_b32 v43, v43, v47, vcc
    v_bfi_b32 v40, 63, s100, v40
    v_bfi_b32 v41, 63, s100, v41
    v_bfi_b32 v42, 63, s100, v42
    v_bfi_b32 v43, 63, s100, v43
    s_mov_b32 exec_lo, 0x30003
    s_mov_b32 exec_hi, 0x30003
    buffer_store_dwordx4 v[40:43], v7, s[32:35], s19 offen sc1
    s_mov_b64 exec, -1
    buffer_load_dwordx4 v[80:83], v2, s[32:35], s20 offen sc1
    buffer_load_dwordx4 v[84:87], v2, s[32:35], s20 offen offset:1024 sc1
    s_waitcnt vmcnt(11)
    s_barrier
    ds_read_b128 v[224:227], v15 offset:0
    ds_read_b64_tr_b16 v[208:209], v9 offset:0
    ds_read_b64_tr_b16 v[210:211], v9 offset:512
    ds_read_b128 v[228:231], v15 offset:32
    ds_read_b64_tr_b16 v[212:213], v9 offset:2048
    ds_read_b64_tr_b16 v[214:215], v9 offset:2560
    ds_read_b128 v[232:235], v15 offset:64
    ds_read_b64_tr_b16 v[216:217], v9 offset:4096
    ds_read_b64_tr_b16 v[218:219], v9 offset:4608
    s_waitcnt lgkmcnt(6)
    v_mfma_f32_32x32x16_bf16 v[192:207], v[208:211], v[224:227], 0
    ds_read_b128 v[236:239], v15 offset:96
    ds_read_b64_tr_b16 v[220:221], v9 offset:6144
    ds_read_b64_tr_b16 v[222:223], v9 offset:6656
    v_lshrrev_b32 v16, 5, v1
    v_lshlrev_b32 v10, 2, v16
    s_waitcnt lgkmcnt(6)
    v_mfma_f32_32x32x16_bf16 v[192:207], v[212:215], v[228:231], v[192:207]
    ds_read_b128 v[224:227], v15 offset:128
    ds_read_b64_tr_b16 v[208:209], v9 offset:8192
    ds_read_b64_tr_b16 v[210:211], v9 offset:8704
    v_lshrrev_b32 v16, 3, v1
    v_and_b32 v4, 0x70, v2
    s_waitcnt lgkmcnt(6)
    v_mfma_f32_32x32x16_bf16 v[192:207], v[216:219], v[232:235], v[192:207]
    ds_read_b128 v[228:231], v15 offset:160
    ds_read_b64_tr_b16 v[212:213], v9 offset:10240
    ds_read_b64_tr_b16 v[214:215], v9 offset:10752
    v_lshl_add_u32 v4, v16, 8, v4
    v_and_b32 v6, 7, v1
    s_waitcnt lgkmcnt(6)
    v_mfma_f32_32x32x16_bf16 v[192:207], v[220:223], v[236:239], v[192:207]
    ds_read_b128 v[232:235], v15 offset:192
    ds_read_b64_tr_b16 v[216:217], v9 offset:12288
    ds_read_b64_tr_b16 v[218:219], v9 offset:12800
    buffer_load_dwordx2 v[88:89], v90, s[32:35], 0 offen sc1
    v_lshl_add_u32 v6, v6, s81, v10
    s_waitcnt lgkmcnt(6)
    v_mfma_f32_32x32x16_bf16 v[192:207], v[208:211], v[224:227], v[192:207]
    ds_read_b128 v[236:239], v15 offset:224
    ds_read_b64_tr_b16 v[220:221], v9 offset:14336
    ds_read_b64_tr_b16 v[222:223], v9 offset:14848
    s_cmp_lt_u32 s82, 0x8000000
    s_cselect_b32 s81, 63, 0
    v_lshlrev_b32 v11, 3, v1
    s_waitcnt lgkmcnt(6)
    v_mfma_f32_32x32x16_bf16 v[192:207], v[212:215], v[228:231], v[192:207]
    ds_read_b128 v[224:227], v15 offset:256
    ds_read_b64_tr_b16 v[208:209], v9 offset:16384
    ds_read_b64_tr_b16 v[210:211], v9 offset:16896
    v_add_u32 v11, s23, v11
    v_add_u32 v3, s23, v2
    s_waitcnt lgkmcnt(6)
    v_mfma_f32_32x32x16_bf16 v[192:207], v[216:219], v[232:235], v[192:207]
    ds_read_b128 v[228:231], v15 offset:288
    ds_read_b64_tr_b16 v[212:213], v9 offset:18432
    ds_read_b64_tr_b16 v[214:215], v9 offset:18944
    v_mov_b32 v16, 0
    v_mov_b32 v17, 0
    s_waitcnt lgkmcnt(6)
    v_mfma_f32_32x32x16_bf16 v[192:207], v[220:223], v[236:239], v[192:207]
    ds_read_b128 v[232:235], v15 offset:320
    ds_read_b64_tr_b16 v[216:217], v9 offset:20480
    ds_read_b64_tr_b16 v[218:219], v9 offset:20992
    v_mov_b32 v18, 0
    v_mov_b32 v19, 0
    s_waitcnt lgkmcnt(6)
    v_mfma_f32_32x32x16_bf16 v[192:207], v[208:211], v[224:227], v[192:207]
    ds_read_b128 v[236:239], v15 offset:352
    ds_read_b64_tr_b16 v[220:221], v9 offset:22528
    ds_read_b64_tr_b16 v[222:223], v9 offset:23040
    ds_write_b128 v3, v[16:19] offset:2048
    s_lshl_b32 s58, s3, 13
    s_waitcnt lgkmcnt(7)
    v_mfma_f32_32x32x16_bf16 v[192:207], v[212:215], v[228:231], v[192:207]
    ds_read_b128 v[224:227], v15 offset:384
    ds_read_b64_tr_b16 v[208:209], v9 offset:24576
    ds_read_b64_tr_b16 v[210:211], v9 offset:25088
    s_lshl_b32 s48, s84, 16
    s_add_u32 s48, s48, s58
    s_waitcnt lgkmcnt(7)
    v_mfma_f32_32x32x16_bf16 v[192:207], v[216:219], v[232:235], v[192:207]
    ds_read_b128 v[228:231], v15 offset:416
    ds_read_b64_tr_b16 v[212:213], v9 offset:26624
    ds_read_b64_tr_b16 v[214:215], v9 offset:27136
    s_add_u32 s48, s48, 9437184
    s_add_u32 s49, s48, 0x1000
    s_waitcnt lgkmcnt(7)
    v_mfma_f32_32x32x16_bf16 v[192:207], v[220:223], v[236:239], v[192:207]
    ds_read_b128 v[232:235], v15 offset:448
    ds_read_b64_tr_b16 v[216:217], v9 offset:28672
    ds_read_b64_tr_b16 v[218:219], v9 offset:29184
    s_add_u32 s50, s48, 0x8000
    s_add_u32 s51, s48, 0x9000
    s_waitcnt lgkmcnt(6)
    v_mfma_f32_32x32x16_bf16 v[192:207], v[208:211], v[224:227], v[192:207]
    ds_read_b128 v[236:239], v15 offset:480
    ds_read_b64_tr_b16 v[220:221], v9 offset:30720
    ds_read_b64_tr_b16 v[222:223], v9 offset:31232
    s_add_u32 s52, s58, 65536
    s_add_u32 s53, s52, 0x1000
    s_waitcnt lgkmcnt(6)
    v_mfma_f32_32x32x16_bf16 v[192:207], v[212:215], v[228:231], v[192:207]
    ds_read_b128 v[224:227], v15 offset:512
    ds_read_b64_tr_b16 v[208:209], v9 offset:32768
    ds_read_b64_tr_b16 v[210:211], v9 offset:33280
    s_lshl_b32 s54, s3, 9
    s_add_u32 s54, s54, 98304
    s_waitcnt lgkmcnt(6)
    v_mfma_f32_32x32x16_bf16 v[192:207], v[216:219], v[232:235], v[192:207]
    ds_read_b128 v[228:231], v15 offset:544
    ds_read_b64_tr_b16 v[212:213], v9 offset:34816
    ds_read_b64_tr_b16 v[214:215], v9 offset:35328
    v_and_b32 v7, 3, v1
    v_lshlrev_b32 v7, 6, v7
    s_waitcnt lgkmcnt(6)
    v_mfma_f32_32x32x16_bf16 v[192:207], v[220:223], v[236:239], v[192:207]
    ds_read_b128 v[232:235], v15 offset:576
    ds_read_b64_tr_b16 v[216:217], v9 offset:36864
    ds_read_b64_tr_b16 v[218:219], v9 offset:37376
    s_waitcnt vmcnt(0)
    v_xor_b32 v88, s100, v88
    v_bitop3_b32 v88, v89, s100, v88 bitop3:0xbe
    v_cmp_ne_u32 vcc, 0, v88
    s_cbranch_vccnz re_3
ok_4:
    v_and_b32 v8, 0x30, v1
    buffer_load_dwordx4 a[0:3], v2, s[32:35], s26 offen offset:0 sc1
    v_add_u32 v7, v7, v8
    s_waitcnt lgkmcnt(6)
    v_mfma_f32_32x32x16_bf16 v[192:207], v[208:211], v[224:227], v[192:207]
    ds_read_b128 v[236:239], v15 offset:608
    ds_read_b64_tr_b16 v[220:221], v9 offset:38912
    ds_read_b64_tr_b16 v[222:223], v9 offset:39424
    v_lshlrev_b32 v8, 2, v10
    buffer_load_dwordx4 a[4:7], v2, s[32:35], s26 offen offset:1024 sc1
    s_lshl_b32 s60, s85, 6
    s_waitcnt lgkmcnt(6)
    v_mfma_f32_32x32x16_bf16 v[192:207], v[212:215], v[228:231], v[192:207]
    ds_read_b128 v[224:227], v15 offset:640
    ds_read_b64_tr_b16 v[208:209], v9 offset:40960
    ds_read_b64_tr_b16 v[210:211], v9 offset:41472
    v_and_b32 v12, 31, v1
    buffer_load_dwordx4 a[8:11], v2, s[32:35], s26 offen offset:2048 sc1
    v_lshl_add_u32 v12, v12, 10, v8
    s_waitcnt lgkmcnt(6)
    v_mfma_f32_32x32x16_bf16 v[192:207], v[216:219], v[232:235], v[192:207]
    ds_read_b128 v[228:231], v15 offset:672
    ds_read_b64_tr_b16 v[212:213], v9 offset:43008
    ds_read_b64_tr_b16 v[214:215], v9 offset:43520
    s_lshl_b32 s61, s84, 15
    buffer_load_dwordx4 a[12:15], v2, s[32:35], s26 offen offset:3072 sc1
    s_add_u32 s61, s61, s60
    s_waitcnt lgkmcnt(6)
    v_mfma_f32_32x32x16_bf16 v[192:207], v[220:223], v[236:239], v[192:207]
    ds_read_b128 v[232:235], v15 offset:704
    ds_read_b64_tr_b16 v[216:217], v9 offset:45056
    ds_read_b64_tr_b16 v[218:219], v9 offset:45568
    v_add_u32 v12, s61, v12
    s_add_u32 s26, s26, 4096
    buffer_load_dwordx4 a[16:19], v2, s[32:35], s26 offen offset:0 sc1
    s_add_u32 s60, s60, 134144
    s_waitcnt lgkmcnt(6)
    v_mfma_f32_32x32x16_bf16 v[192:207], v[208:211], v[224:227], v[192:207]
    ds_read_b128 v[236:239], v15 offset:736
    ds_read_b64_tr_b16 v[220:221], v9 offset:47104
    ds_read_b64_tr_b16 v[222:223], v9 offset:47616
    v_add_u32 v8, s60, v8
    buffer_load_dwordx4 a[20:23], v2, s[32:35], s26 offen offset:1024 sc1
    v_and_b32 v13, 0xf0, v2
    s_waitcnt lgkmcnt(6)
    v_mfma_f32_32x32x16_bf16 v[192:207], v[212:215], v[228:231], v[192:207]
    ds_read_b128 v[224:227], v15 offset:768
    ds_read_b64_tr_b16 v[208:209], v9 offset:49152
    ds_read_b64_tr_b16 v[210:211], v9 offset:49664
    v_lshrrev_b32 v29, 4, v1
    buffer_load_dwordx4 a[24:27], v2, s[32:35], s26 offen offset:2048 sc1
    v_lshl_add_u32 v13, v29, 9, v13
    s_waitcnt lgkmcnt(6)
    v_mfma_f32_32x32x16_bf16 v[192:207], v[216:219], v[232:235], v[192:207]
    ds_read_b128 v[228:231], v15 offset:800
    ds_read_b64_tr_b16 v[212:213], v9 offset:51200
    ds_read_b64_tr_b16 v[214:215], v9 offset:51712
    v_add_u32 v13, s58, v13
    buffer_load_dwordx4 a[28:31], v2, s[32:35], s26 offen offset:3072 sc1
    s_waitcnt lgkmcnt(6)
    v_mfma_f32_32x32x16_bf16 v[192:207], v[220:223], v[236:239], v[192:207]
    ds_read_b128 v[232:235], v15 offset:832
    ds_read_b64_tr_b16 v[216:217], v9 offset:53248
    ds_read_b64_tr_b16 v[218:219], v9 offset:53760
    s_waitcnt lgkmcnt(6)
    v_mfma_f32_32x32x16_bf16 v[192:207], v[208:211], v[224:227], v[192:207]
    s_add_u32 s26, s26, 4096
    buffer_load_dwordx4 a[32:35], v2, s[32:35], s26 offen offset:0 sc1
    ds_read_b128 v[236:239], v15 offset:864
    ds_read_b64_tr_b16 v[220:221], v9 offset:55296
    ds_read_b64_tr_b16 v[222:223], v9 offset:55808
    s_waitcnt lgkmcnt(6)
    v_mfma_f32_32x32x16_bf16 v[192:207], v[212:215], v[228:231], v[192:207]
    ds_read_b128 v[224:227], v15 offset:896
    ds_read_b64_tr_b16 v[208:209], v9 offset:57344
    buffer_load_dwordx4 a[36:39], v2, s[32:35], s26 offen offset:1024 sc1
    ds_read_b64_tr_b16 v[210:211], v9 offset:57856
    s_waitcnt lgkmcnt(6)
    v_mfma_f32_32x32x16_bf16 v[192:207], v[216:219], v[232:235], v[192:207]
    ds_read_b128 v[228:231], v15 offset:928
    ds_read_b64_tr_b16 v[212:213], v9 offset:59392
    ds_read_b64_tr_b16 v[214:215], v9 offset:59904
    buffer_load_dwordx4 v[16:19], v4, s[32:35], s82 offen sc1
    buffer_load_dwordx4 v[20:23], v4, s[32:35], s82 offen offset:2048 sc1
    buffer_load_dwordx4 v[24:27], v4, s[32:35], s22 offen sc1
    buffer_load_dwordx4 v[28:31], v4, s[32:35], s22 offen offset:2048 sc1
    s_waitcnt lgkmcnt(6)
    v_mfma_f32_32x32x16_bf16 v[192:207], v[220:223], v[236:239], v[192:207]
    ds_read_b128 v[232:235], v15 offset:960
    ds_read_b64_tr_b16 v[216:217], v9 offset:61440
    ds_read_b64_tr_b16 v[218:219], v9 offset:61952
    s_waitcnt lgkmcnt(6)
    v_mfma_f32_32x32x16_bf16 v[192:207], v[208:211], v[224:227], v[192:207]
    ds_read_b128 v[236:239], v15 offset:992
    ds_read_b64_tr_b16 v[220:221], v9 offset:63488
    ds_read_b64_tr_b16 v[222:223], v9 offset:64000
    s_waitcnt lgkmcnt(6)
    v_mfma_f32_32x32x16_bf16 v[192:207], v[212:215], v[228:231], v[192:207]
    s_waitcnt lgkmcnt(3)
    v_mfma_f32_32x32x16_bf16 v[192:207], v[216:219], v[232:235], v[192:207]
    s_waitcnt lgkmcnt(0)
    v_mfma_f32_32x32x16_bf16 v[192:207], v[220:223], v[236:239], v[192:207]
    s_nop 11
    v_cvt_pk_bf16_f32 v192, v192, v193
    buffer_load_dwordx4 a[40:43], v2, s[32:35], s26 offen offset:2048 sc1
    v_cvt_pk_bf16_f32 v193, v194, v195
    v_cvt_pk_bf16_f32 v194, v196, v197
    v_cvt_pk_bf16_f32 v195, v198, v199
    v_cvt_pk_bf16_f32 v196, v200, v201
    v_cvt_pk_bf16_f32 v197, v202, v203
    v_cvt_pk_bf16_f32 v198, v204, v205
    v_cvt_pk_bf16_f32 v199, v206, v207
    v_mfma_f32_32x32x16_bf16 v[240:255], v[52:55], v[192:195], 0
    s_nop 0
    v_mfma_f32_32x32x16_bf16 v[208:223], v[56:59], v[196:199], 0
    buffer_load_dwordx4 a[44:47], v2, s[32:35], s26 offen offset:3072 sc1
    v_xor_b32 v32, s100, v82
    v_bitop3_b32 v32, v83, s100, v32 bitop3:0xbe
    v_bitop3_b32 v32, v86, s100, v32 bitop3:0xbe
    v_bitop3_b32 v32, v87, s100, v32 bitop3:0xbe
    v_cmp_ne_u32 vcc, 0, v32
    s_cbranch_vccnz re_5
ok_6:
    ds_write_b64 v11, v[80:81]
    ds_write_b64 v11, v[84:85] offset:512
    s_add_u32 s26, s26, 4096
    buffer_load_dwordx4 a[48:51], v2, s[32:35], s26 offen offset:0 sc1
    v_max3_f32 v60, v240, v241, v242
    v_max3_f32 v61, v243, v244, v245
    v_max3_f32 v60, v60, v246, v247
    v_max3_f32 v61, v61, v248, v249
    v_max3_f32 v60, v60, v250, v251
    v_max3_f32 v61, v61, v252, v253
    v_max3_f32 v60, v60, v254, v255
    v_max_f32 v60, v60, v61
    v_mul_f32 v60, 0xbfb8aa3b, v60
    v_pk_fma_f32 v[240:241], v[240:241], s[46:47], v[60:61] op_sel_hi:[1,0,0]
    buffer_load_dwordx4 a[52:55], v2, s[32:35], s26 offen offset:1024 sc1
    v_pk_fma_f32 v[242:243], v[242:243], s[46:47], v[60:61] op_sel_hi:[1,0,0]
    v_pk_fma_f32 v[244:245], v[244:245], s[46:47], v[60:61] op_sel_hi:[1,0,0]
    v_pk_fma_f32 v[246:247], v[246:247], s[46:47], v[60:61] op_sel_hi:[1,0,0]
    v_pk_fma_f32 v[248:249], v[248:249], s[46:47], v[60:61] op_sel_hi:[1,0,0]
    v_pk_fma_f32 v[250:251], v[250:251], s[46:47], v[60:61] op_sel_hi:[1,0,0]
    v_pk_fma_f32 v[252:253], v[252:253], s[46:47], v[60:61] op_sel_hi:[1,0,0]
    v_pk_fma_f32 v[254:255], v[254:255], s[46:47], v[60:61] op_sel_hi:[1,0,0]
    v_exp_f32 v240, v240
    v_exp_f32 v241, v241
    buffer_load_dwordx4 a[56:59], v2, s[32:35], s26 offen offset:2048 sc1
    v_exp_f32 v242, v242
    v_exp_f32 v243, v243
    v_exp_f32 v244, v244
    v_exp_f32 v245, v245
    v_exp_f32 v246, v246
    buffer_load_dwordx4 a[60:63], v2, s[32:35], s26 offen offset:3072 sc1
    v_exp_f32 v247, v247
    v_exp_f32 v248, v248
    v_exp_f32 v249, v249
    v_exp_f32 v250, v250
    v_exp_f32 v251, v251
    s_add_u32 s26, s26, 4096
    buffer_load_dwordx4 a[64:67], v2, s[32:35], s26 offen offset:0 sc1
    v_exp_f32 v252, v252
    v_exp_f32 v253, v253
    v_exp_f32 v254, v254
    v_exp_f32 v255, v255
    v_pk_add_f32 v[60:61], v[240:241], v[242:243]
    v_pk_add_f32 v[62:63], v[244:245], v[246:247]
    buffer_load_dwordx4 a[68:71], v2, s[32:35], s26 offen offset:1024 sc1
    v_pk_add_f32 v[60:61], v[60:61], v[248:249]
    v_pk_add_f32 v[62:63], v[62:63], v[250:251]
    v_pk_add_f32 v[60:61], v[60:61], v[252:253]
    v_pk_add_f32 v[62:63], v[62:63], v[254:255]
    v_pk_add_f32 v[60:61], v[60:61], v[62:63]
    v_add_f32 v60, v60, v61
    v_rcp_f32 v60, v60
    s_nop 0
    v_pk_mul_f32 v[240:241], v[240:241], v[60:61] op_sel_hi:[1,0]
    buffer_load_dwordx4 a[72:75], v2, s[32:35], s26 offen offset:2048 sc1
    v_pk_mul_f32 v[242:243], v[242:243], v[60:61] op_sel_hi:[1,0]
    v_pk_mul_f32 v[244:245], v[244:245], v[60:61] op_sel_hi:[1,0]
    v_pk_mul_f32 v[246:247], v[246:247], v[60:61] op_sel_hi:[1,0]
    v_pk_mul_f32 v[248:249], v[248:249], v[60:61] op_sel_hi:[1,0]
    v_pk_mul_f32 v[250:251], v[250:251], v[60:61] op_sel_hi:[1,0]
    v_pk_mul_f32 v[252:253], v[252:253], v[60:61] op_sel_hi:[1,0]
    v_pk_mul_f32 v[254:255], v[254:255], v[60:61] op_sel_hi:[1,0]
    v_cvt_pk_bf16_f32 v240, v240, v241
    v_cvt_pk_bf16_f32 v241, v242, v243
    v_cvt_pk_bf16_f32 v242, v244, v245
    buffer_load_dwordx4 a[76:79], v2, s[32:35], s26 offen offset:3072 sc1
    v_cvt_pk_bf16_f32 v243, v246, v247
    v_cvt_pk_bf16_f32 v244, v248, v249
    v_cvt_pk_bf16_f32 v245, v250, v251
    v_cvt_pk_bf16_f32 v246, v252, v253
    v_cvt_pk_bf16_f32 v247, v254, v255
    v_or_b32 v240, s101, v240
    v_or_b32 v243, s101, v243
    v_or_b32 v244, s101, v244
    v_or_b32 v247, s101, v247
    s_waitcnt vmcnt(10)
    v_xor_b32 v32, s100, v16
    v_xor_b32 v33, s100, v17
    v_bitop3_b32 v32, v18, s100, v32 bitop3:0xbe
    v_bitop3_b32 v33, v19, s100, v33 bitop3:0xbe
    v_bitop3_b32 v32, v20, s100, v32 bitop3:0xbe
    v_bitop3_b32 v33, v21, s100, v33 bitop3:0xbe
    v_bitop3_b32 v32, v22, s100, v32 bitop3:0xbe
    v_bitop3_b32 v33, v23, s100, v33 bitop3:0xbe
    v_bitop3_b32 v32, v24, s100, v32 bitop3:0xbe
    v_bitop3_b32 v33, v25, s100, v33 bitop3:0xbe
    v_bitop3_b32 v32, v26, s100, v32 bitop3:0xbe
    v_bitop3_b32 v33, v27, s100, v33 bitop3:0xbe
    v_bitop3_b32 v32, v28, s100, v32 bitop3:0xbe
    v_bitop3_b32 v33, v29, s100, v33 bitop3:0xbe
    v_bitop3_b32 v32, v30, s100, v32 bitop3:0xbe
    v_bitop3_b32 v33, v31, s100, v33 bitop3:0xbe
    v_or_b32 v32, v32, v33
    v_and_b32 v32, s81, v32
    v_cmp_ne_u32 vcc, 0, v32
    s_cbranch_vccnz re_7
ok_8:
    v_pk_add_f32 v[16:17], v[16:17], v[20:21]
    v_pk_add_f32 v[18:19], v[18:19], v[22:23]
    v_pk_add_f32 v[24:25], v[24:25], v[28:29]
    v_pk_add_f32 v[26:27], v[26:27], v[30:31]
    v_pk_add_f32 v[16:17], v[16:17], v[24:25]
    v_pk_add_f32 v[18:19], v[18:19], v[26:27]
    s_nop 1
    v_permlane32_swap_b32 v16, v18
    v_permlane32_swap_b32 v17, v19
    v_pk_add_f32 v[16:17], v[16:17], v[18:19]
    v_mov_b32 v18, v16
    v_mov_b32 v19, v17
    s_nop 0
    v_permlane16_swap_b32 v16, v18
    v_permlane16_swap_b32 v17, v19
    v_pk_add_f32 v[16:17], v[16:17], v[18:19]
    s_nop 1
    v_add_f32_dpp v16, v16, v16 row_ror:8 row_mask:0xf bank_mask:0xf
    v_add_f32_dpp v17, v17, v17 row_ror:8 row_mask:0xf bank_mask:0xf
    v_cvt_pk_bf16_f32 v16, v16, v17
    s_mov_b32 exec_lo, 0xff
    s_mov_b32 exec_hi, 0xff
    buffer_store_dword v16, v6, s[32:35], s80 offen sc1
    s_mov_b64 exec, -1
    buffer_store_dwordx4 v[240:243], v14, s[32:35], s21 offen offset:0 sc1
    buffer_store_dwordx4 v[244:247], v14, s[32:35], s21 offen offset:256 sc1
    s_branch S_3
T_3:
    s_branch T_7
S_3:
    v_max3_f32 v60, v208, v209, v210
    v_max3_f32 v61, v211, v212, v213
    v_max3_f32 v60, v60, v214, v215
    v_max3_f32 v61, v61, v216, v217
    v_max3_f32 v60, v60, v218, v219
    v_max3_f32 v61, v61, v220, v221
    v_max3_f32 v60, v60, v222, v223
    v_max_f32 v60, v60, v61
    v_mul_f32 v60, 0xbfb8aa3b, v60
    v_pk_fma_f32 v[208:209], v[208:209], s[46:47], v[60:61] op_sel_hi:[1,0,0]
    v_pk_fma_f32 v[210:211], v[210:211], s[46:47], v[60:61] op_sel_hi:[1,0,0]
    v_pk_fma_f32 v[212:213], v[212:213], s[46:47], v[60:61] op_sel_hi:[1,0,0]
    v_pk_fma_f32 v[214:215], v[214:215], s[46:47], v[60:61] op_sel_hi:[1,0,0]
    v_pk_fma_f32 v[216:217], v[216:217], s[46:47], v[60:61] op_sel_hi:[1,0,0]
    v_pk_fma_f32 v[218:219], v[218:219], s[46:47], v[60:61] op_sel_hi:[1,0,0]
    v_pk_fma_f32 v[220:221], v[220:221], s[46:47], v[60:61] op_sel_hi:[1,0,0]
    v_pk_fma_f32 v[222:223], v[222:223], s[46:47], v[60:61] op_sel_hi:[1,0,0]
    v_exp_f32 v208, v208
    v_exp_f32 v209, v209
    v_exp_f32 v210, v210
    v_exp_f32 v211, v211
    v_exp_f32 v212, v212
    v_exp_f32 v213, v213
    v_exp_f32 v214, v214
    v_exp_f32 v215, v215
    v_exp_f32 v216, v216
    v_exp_f32 v217, v217
    v_exp_f32 v218, v218
    v_exp_f32 v219, v219
    v_exp_f32 v220, v220
    v_exp_f32 v221, v221
    v_exp_f32 v222, v222
    v_exp_f32 v223, v223
    v_pk_add_f32 v[60:61], v[208:209], v[210:211]
    v_pk_add_f32 v[62:63], v[212:213], v[214:215]
    v_pk_add_f32 v[60:61], v[60:61], v[216:217]
    v_pk_add_f32 v[62:63], v[62:63], v[218:219]
    v_pk_add_f32 v[60:61], v[60:61], v[220:221]
    v_pk_add_f32 v[62:63], v[62:63], v[222:223]
    v_pk_add_f32 v[60:61], v[60:61], v[62:63]
    v_add_f32 v60, v60, v61
    v_rcp_f32 v60, v60
    s_nop 0
    v_pk_mul_f32 v[208:209], v[208:209], v[60:61] op_sel_hi:[1,0]
    s_add_u32 s26, s26, 4096
    buffer_load_dwordx4 a[80:83], v2, s[32:35], s26 offen offset:0 sc1
    v_pk_mul_f32 v[210:211], v[210:211], v[60:61] op_sel_hi:[1,0]
    v_pk_mul_f32 v[212:213], v[212:213], v[60:61] op_sel_hi:[1,0]
    v_pk_mul_f32 v[214:215], v[214:215], v[60:61] op_sel_hi:[1,0]
    v_pk_mul_f32 v[216:217], v[216:217], v[60:61] op_sel_hi:[1,0]
    v_pk_mul_f32 v[218:219], v[218:219], v[60:61] op_sel_hi:[1,0]
    v_pk_mul_f32 v[220:221], v[220:221], v[60:61] op_sel_hi:[1,0]
    v_pk_mul_f32 v[222:223], v[222:223], v[60:61] op_sel_hi:[1,0]
    v_cvt_pk_bf16_f32 v208, v208, v209
    v_cvt_pk_bf16_f32 v209, v210, v211
    v_cvt_pk_bf16_f32 v210, v212, v213
    buffer_load_dwordx4 a[84:87], v2, s[32:35], s26 offen offset:1024 sc1
    v_cvt_pk_bf16_f32 v211, v214, v215
    v_cvt_pk_bf16_f32 v212, v216, v217
    v_cvt_pk_bf16_f32 v213, v218, v219
    v_cvt_pk_bf16_f32 v214, v220, v221
    v_cvt_pk_bf16_f32 v215, v222, v223
    v_or_b32 v208, s101, v208
    v_or_b32 v211, s101, v211
    v_or_b32 v212, s101, v212
    v_or_b32 v215, s101, v215
    buffer_store_dwordx4 v[208:211], v14, s[32:35], s21 offen offset:1024 sc1
    buffer_store_dwordx4 v[212:215], v14, s[32:35], s21 offen offset:1280 sc1
    v_and_b32 v3, 1, v1
    s_movk_i32 s60, 7168
    v_mul_u32_u24 v3, s60, v3
    v_sub_u32 v3, 148480, v3
    v_lshl_add_u32 v3, v10, 2, v3
    s_add_u32 s23, s23, 2048
    v_mov_b32 v9, s23
    s_mov_b32 vcc_lo, 0x300003
    s_mov_b32 vcc_hi, 0x300003
    v_cndmask_b32 v9, v9, v3, vcc
    s_waitcnt lgkmcnt(0)
    s_barrier
    ds_read_b128 v[176:179], v8
    ds_read_b128 v[180:183], v8 offset:32
    ds_read_b128 v[184:187], v8 offset:14336
    ds_read_b128 v[188:191], v8 offset:14368
    ds_read_b128 v[224:227], v9 offset:0
    ds_read_b128 v[228:231], v9 offset:32
    ds_read_b128 v[232:235], v9 offset:64
    ds_read_b128 v[236:239], v9 offset:96
    ds_read_b128 v[240:243], v9 offset:128
    ds_read_b128 v[244:247], v9 offset:160
    ds_read_b128 v[248:251], v9 offset:192
    s_waitcnt lgkmcnt(6)
    v_mfma_f32_16x16x32_bf16 v[40:43], v[224:227], a[0:3], 0
    ds_read_b128 v[252:255], v9 offset:224
    s_and_b32 s71, s3, 1
    s_lshl_b32 s60, s87, 2
    s_lshl_b32 s61, s71, 1
    s_add_u32 s10, s60, s61
    s_xor_b32 s14, s10, 2
    s_mul_i32 s10, s10, 86
    s_waitcnt lgkmcnt(6)
    v_mfma_f32_16x16x32_bf16 v[44:47], v[228:231], a[4:7], 0
    ds_read_b128 v[224:227], v9 offset:256
    s_mul_i32 s14, s14, 86
    s_add_u32 s11, s10, s90
    s_add_u32 s10, s10, s89
    s_add_u32 s14, s14, s89
    s_lshl_b32 s10, s10, 10
    s_lshl_b32 s14, s14, 10
    s_waitcnt lgkmcnt(6)
    v_mfma_f32_16x16x32_bf16 v[40:43], v[232:235], a[8:11], v[40:43]
    ds_read_b128 v[228:231], v9 offset:288
    s_lshl_b32 s11, s11, 10
    buffer_load_dwordx4 a[88:91], v2, s[32:35], s26 offen offset:2048 sc1
    s_add_u32 s10, s10, 17825792
    s_add_u32 s14, s14, 17825792
    s_add_u32 s11, s11, 17825792
    s_cmp_gt_u32 s90, 53
    s_cselect_b32 s11, 0x8000000, s11
    s_add_u32 s12, s10, 88064
    s_waitcnt lgkmcnt(6)
    v_mfma_f32_16x16x32_bf16 v[44:47], v[236:239], a[12:15], v[44:47]
    ds_read_b128 v[232:235], v9 offset:320
    buffer_load_dwordx4 a[92:95], v2, s[32:35], s26 offen offset:3072 sc1
    s_add_u32 s13, s11, 88064
    s_add_u32 s15, s14, 88064
    s_lshl_b32 s18, s87, 17
    s_lshl_b32 s55, s3, 12
    s_add_u32 s18, s18, s55
    s_add_u32 s18, s18, 13631488
    s_waitcnt lgkmcnt(6)
    v_mfma_f32_16x16x32_bf16 v[40:43], v[240:243], a[16:19], v[40:43]
    ds_read_b128 v[236:239], v9 offset:352
    s_add_u32 s26, s26, 4096
    buffer_load_dwordx4 a[96:99], v2, s[32:35], s26 offen offset:0 sc1
    s_add_u32 s19, s60, s3
    s_lshl_b32 s19, s19, 12
    s_add_u32 s19, s19, 131072
    s_and_b32 s61, s88, 1
    s_lshl_b32 s64, s61, 1
    s_add_u32 s64, s64, s60
    s_waitcnt lgkmcnt(6)
    v_mfma_f32_16x16x32_bf16 v[44:47], v[244:247], a[20:23], v[44:47]
    ds_read_b128 v[240:243], v9 offset:384
    buffer_load_dwordx4 a[100:103], v2, s[32:35], s26 offen offset:1024 sc1
    s_lshr_b32 s45, s3, 1
    s_add_u32 s44, s64, s45
    s_and_b32 s45, s88, 14
    s_add_u32 s45, s45, s71
    s_mul_i32 s62, s3, 27
    s_add_u32 s62, s62, 1
    s_waitcnt lgkmcnt(6)
    v_mfma_f32_16x16x32_bf16 v[40:43], v[248:251], a[24:27], v[40:43]
    ds_read_b128 v[244:247], v9 offset:416
    buffer_load_dwordx4 a[104:107], v2, s[32:35], s26 offen offset:2048 sc1
    s_lshr_b32 s62, s62, 1
    s_lshl_b32 s63, s61, 5
    s_add_u32 s62, s62, s63
    s_xor_b32 s63, s61, 1
    s_mul_i32 s63, s63, 54
    s_lshl_b32 s61, s3, 3
    s_waitcnt lgkmcnt(6)
    v_mfma_f32_16x16x32_bf16 v[44:47], v[252:255], a[28:31], v[44:47]
    ds_read_b128 v[248:251], v9 offset:448
    buffer_load_dwordx4 a[108:111], v2, s[32:35], s26 offen offset:3072 sc1
    s_add_u32 s63, s63, s61
    s_mul_i32 s20, s45, 86
    s_xor_b32 s21, s45, 1
    s_mul_i32 s21, s21, 86
    s_add_u32 s22, s20, s63
    s_add_u32 s72, s21, s63
    s_waitcnt lgkmcnt(6)
    v_mfma_f32_16x16x32_bf16 v[40:43], v[224:227], a[32:35], v[40:43]
    ds_read_b128 v[252:255], v9 offset:480
    s_add_u32 s26, s26, 4096
    buffer_load_dwordx4 a[112:115], v2, s[32:35], s26 offen offset:0 sc1
    s_add_u32 s20, s20, s62
    s_add_u32 s21, s21, s62
    s_lshl_b32 s20, s20, 10
    s_lshl_b32 s21, s21, 10
    s_lshl_b32 s22, s22, 10
    s_lshl_b32 s72, s72, 10
    s_waitcnt lgkmcnt(6)
    v_mfma_f32_16x16x32_bf16 v[44:47], v[228:231], a[36:39], v[44:47]
    ds_read_b128 v[224:227], v9 offset:512
    buffer_load_dwordx4 a[116:119], v2, s[32:35], s26 offen offset:1024 sc1
    s_add_u32 s20, s20, 1572864
    s_add_u32 s21, s21, 1572864
    s_add_u32 s22, s22, 1572864
    s_mul_i32 s64, s64, 86
    s_add_u32 s66, s64, s63
    s_add_u32 s64, s64, s62
    s_waitcnt vmcnt(24) lgkmcnt(6)
    v_mfma_f32_16x16x32_bf16 v[40:43], v[232:235], a[40:43], v[40:43]
    ds_read_b128 v[228:231], v9 offset:544
    buffer_load_dwordx4 a[120:123], v2, s[32:35], s26 offen offset:2048 sc1
    s_lshl_b32 s64, s64, 10
    s_lshl_b32 s66, s66, 10
    s_add_u32 s64, s64, 17825792
    s_add_u32 s66, s66, 17825792
    s_add_u32 s65, s64, 88064
    s_add_u32 s67, s66, 88064
    s_waitcnt vmcnt(24) lgkmcnt(6)
    v_mfma_f32_16x16x32_bf16 v[44:47], v[236:239], a[44:47], v[44:47]
    ds_read_b128 v[232:235], v9 offset:576
    buffer_load_dwordx4 a[124:127], v2, s[32:35], s26 offen offset:3072 sc1
    s_lshl_b32 s68, s44, 4
    s_add_u32 s68, s68, s45
    s_lshl_b32 s68, s68, 11
    s_add_u32 s68, s68, 15728640
    s_lshl_b32 s70, s45, 6
    s_lshl_b32 s69, s44, 15
    s_waitcnt vmcnt(24) lgkmcnt(6)
    v_mfma_f32_16x16x32_bf16 v[40:43], v[240:243], a[48:51], v[40:43]
    ds_read_b128 v[236:239], v9 offset:608
    buffer_load_dwordx4 a[128:131], v2, s[32:35], s86 offen offset:0 sc1
    s_add_u32 s69, s69, s70
    s_add_u32 s70, s70, 155648
    s_add_u32 s23, s72, 1572864
    v_lshlrev_b32 v3, 3, v1
    v_add_u32 v4, s55, v2
    s_lshl_b32 s60, s71, 14
    s_waitcnt vmcnt(24) lgkmcnt(6)
    v_mfma_f32_16x16x32_bf16 v[44:47], v[244:247], a[52:55], v[44:47]
    ds_read_b128 v[240:243], v9 offset:640
    buffer_load_dwordx4 a[132:135], v2, s[32:35], s86 offen offset:1024 sc1
    s_add_u32 s27, s27, s60
    s_lshr_b32 s73, s3, 1
    s_lshl_b32 s73, s73, 16
    s_add_u32 s73, s73, 32768
    v_add_u32 v5, s73, v2
    s_add_u32 s73, s73, s60
    s_waitcnt vmcnt(24) lgkmcnt(6)
    v_mfma_f32_16x16x32_bf16 v[40:43], v[248:251], a[56:59], v[40:43]
    ds_read_b128 v[244:247], v9 offset:672
    buffer_load_dwordx4 a[136:139], v2, s[32:35], s86 offen offset:2048 sc1
    v_lshlrev_b32 v192, 16, v176
    v_and_b32 v193, 0xffff0000, v176
    v_lshlrev_b32 v194, 16, v177
    v_and_b32 v195, 0xffff0000, v177
    v_lshlrev_b32 v196, 16, v178
    v_and_b32 v197, 0xffff0000, v178
    s_waitcnt vmcnt(24) lgkmcnt(6)
    v_mfma_f32_16x16x32_bf16 v[44:47], v[252:255], a[60:63], v[44:47]
    ds_read_b128 v[248:251], v9 offset:704
    global_load_dwordx4 v[168:171], v12, s[4:5]
    v_lshlrev_b32 v198, 16, v179
    v_and_b32 v199, 0xffff0000, v179
    v_lshlrev_b32 v200, 16, v180
    v_and_b32 v201, 0xffff0000, v180
    v_lshlrev_b32 v202, 16, v181
    v_and_b32 v203, 0xffff0000, v181
    s_waitcnt vmcnt(24) lgkmcnt(6)
    v_mfma_f32_16x16x32_bf16 v[40:43], v[224:227], a[64:67], v[40:43]
    ds_read_b128 v[252:255], v9 offset:736
    global_load_dwordx4 v[172:175], v12, s[4:5] offset:32
    v_lshlrev_b32 v204, 16, v182
    v_and_b32 v205, 0xffff0000, v182
    v_lshlrev_b32 v206, 16, v183
    v_and_b32 v207, 0xffff0000, v183
    v_lshlrev_b32 v208, 16, v184
    v_and_b32 v209, 0xffff0000, v184
    s_waitcnt vmcnt(24) lgkmcnt(6)
    v_mfma_f32_16x16x32_bf16 v[44:47], v[228:231], a[68:71], v[44:47]
    ds_read_b128 v[224:227], v9 offset:768
    buffer_load_dwordx4 v[64:67], v2, s[32:35], s48 offen offset:0 sc1
    v_lshlrev_b32 v210, 16, v185
    v_and_b32 v211, 0xffff0000, v185
    v_lshlrev_b32 v212, 16, v186
    v_and_b32 v213, 0xffff0000, v186
    v_lshlrev_b32 v214, 16, v187
    v_and_b32 v215, 0xffff0000, v187
    s_waitcnt vmcnt(24) lgkmcnt(6)
    v_mfma_f32_16x16x32_bf16 v[40:43], v[232:235], a[72:75], v[40:43]
    ds_read_b128 v[228:231], v9 offset:800
    buffer_load_dwordx4 v[68:71], v2, s[32:35], s48 offen offset:1024 sc1
    v_lshlrev_b32 v216, 16, v188
    v_and_b32 v217, 0xffff0000, v188
    v_lshlrev_b32 v218, 16, v189
    v_and_b32 v219, 0xffff0000, v189
    v_lshlrev_b32 v220, 16, v190
    v_and_b32 v221, 0xffff0000, v190
    s_waitcnt vmcnt(24) lgkmcnt(6)
    v_mfma_f32_16x16x32_bf16 v[44:47], v[236:239], a[76:79], v[44:47]
    ds_read_b128 v[232:235], v9 offset:832
    buffer_load_dwordx4 v[72:75], v2, s[32:35], s48 offen offset:2048 sc1
    v_lshlrev_b32 v222, 16, v191
    v_and_b32 v223, 0xffff0000, v191
    s_waitcnt vmcnt(21) lgkmcnt(6)
    v_mfma_f32_16x16x32_bf16 v[40:43], v[240:243], a[80:83], v[40:43]
    ds_read_b128 v[236:239], v9 offset:864
    s_waitcnt vmcnt(20) lgkmcnt(6)
    v_mfma_f32_16x16x32_bf16 v[44:47], v[244:247], a[84:87], v[44:47]
    buffer_load_dwordx4 v[76:79], v2, s[32:35], s48 offen offset:3072 sc1
    ds_read_b128 v[240:243], v9 offset:896
    s_waitcnt vmcnt(18) lgkmcnt(6)
    v_mfma_f32_16x16x32_bf16 v[40:43], v[248:251], a[88:91], v[40:43]
    ds_read_b128 v[244:247], v9 offset:928
    s_waitcnt vmcnt(17) lgkmcnt(6)
    v_mfma_f32_16x16x32_bf16 v[44:47], v[252:255], a[92:95], v[44:47]
    ds_read_b128 v[248:251], v9 offset:960
    buffer_load_dwordx4 v[80:83], v2, s[32:35], s49 offen offset:0 sc1
    s_waitcnt vmcnt(17) lgkmcnt(6)
    v_mfma_f32_16x16x32_bf16 v[40:43], v[224:227], a[96:99], v[40:43]
    ds_read_b128 v[252:255], v9 offset:992
    s_waitcnt vmcnt(16) lgkmcnt(6)
    v_mfma_f32_16x16x32_bf16 v[44:47], v[228:231], a[100:103], v[44:47]
    s_waitcnt vmcnt(15) lgkmcnt(5)
    v_mfma_f32_16x16x32_bf16 v[40:43], v[232:235], a[104:107], v[40:43]
    buffer_load_dwordx4 v[84:87], v2, s[32:35], s49 offen offset:1024 sc1
    s_waitcnt vmcnt(15) lgkmcnt(4)
    v_mfma_f32_16x16x32_bf16 v[44:47], v[236:239], a[108:111], v[44:47]
    s_waitcnt vmcnt(14) lgkmcnt(3)
    v_mfma_f32_16x16x32_bf16 v[40:43], v[240:243], a[112:115], v[40:43]
    s_waitcnt vmcnt(13) lgkmcnt(2)
    v_mfma_f32_16x16x32_bf16 v[44:47], v[244:247], a[116:119], v[44:47]
    buffer_load_dwordx4 v[88:91], v2, s[32:35], s49 offen offset:2048 sc1
    s_waitcnt vmcnt(13) lgkmcnt(1)
    v_mfma_f32_16x16x32_bf16 v[40:43], v[248:251], a[120:123], v[40:43]
    s_waitcnt vmcnt(12) lgkmcnt(0)
    v_mfma_f32_16x16x32_bf16 v[44:47], v[252:255], a[124:127], v[44:47]
    s_nop 7
    v_add_f32 v40, v40, v44
    v_add_f32 v41, v41, v45
    buffer_load_dwordx4 v[92:95], v2, s[32:35], s49 offen offset:3072 sc1
    v_cvt_pk_bf16_f32 v184, v40, v41
    v_lshlrev_b32 v186, 16, v184
    v_and_b32 v187, 0xffff0000, v184
    v_sub_f32 v40, v40, v186
    v_sub_f32 v41, v41, v187
    v_mov_b32 v185, v184
    v_cvt_pk_bf16_f32 v186, v40, v41
    v_cvt_pk_bf16_f32 v187, v40, v41
    buffer_load_dwordx4 v[96:99], v2, s[32:35], s50 offen offset:0 sc1
    buffer_load_dwordx4 v[100:103], v2, s[32:35], s50 offen offset:1024 sc1
    buffer_load_dwordx4 v[104:107], v2, s[32:35], s50 offen offset:2048 sc1
    buffer_load_dwordx4 v[108:111], v2, s[32:35], s50 offen offset:3072 sc1
    buffer_load_dwordx4 v[112:115], v2, s[32:35], s51 offen offset:0 sc1
    buffer_load_dwordx4 v[116:119], v2, s[32:35], s51 offen offset:1024 sc1
    buffer_load_dwordx4 v[120:123], v2, s[32:35], s51 offen offset:2048 sc1
    buffer_load_dwordx4 v[124:127], v2, s[32:35], s51 offen offset:3072 sc1
    buffer_load_dwordx4 v[128:131], v2, s[32:35], s52 offen offset:0 sc1
    buffer_load_dwordx4 v[132:135], v2, s[32:35], s52 offen offset:1024 sc1
    buffer_load_dwordx4 v[136:139], v2, s[32:35], s52 offen offset:2048 sc1
    buffer_load_dwordx4 v[140:143], v2, s[32:35], s52 offen offset:3072 sc1
    buffer_load_dwordx4 v[144:147], v2, s[32:35], s53 offen offset:0 sc1
    buffer_load_dwordx4 v[148:151], v2, s[32:35], s53 offen offset:1024 sc1
    buffer_load_dwordx4 v[152:155], v2, s[32:35], s53 offen offset:2048 sc1
    buffer_load_dwordx4 v[156:159], v2, s[32:35], s53 offen offset:3072 sc1
    buffer_load_dwordx4 v[160:163], v7, s[32:35], s54 offen sc1
    buffer_load_dwordx4 v[164:167], v7, s[32:35], s54 offen offset:256 sc1
    s_waitcnt vmcnt(26)
    v_lshlrev_b32 v224, 16, v168
    v_and_b32 v225, 0xffff0000, v168
    v_lshlrev_b32 v226, 16, v169
    v_and_b32 v227, 0xffff0000, v169
    v_lshlrev_b32 v228, 16, v170
    v_and_b32 v229, 0xffff0000, v170
    v_lshlrev_b32 v230, 16, v171
    v_and_b32 v231, 0xffff0000, v171
    v_lshlrev_b32 v232, 16, v172
    v_and_b32 v233, 0xffff0000, v172
    v_lshlrev_b32 v234, 16, v173
    v_and_b32 v235, 0xffff0000, v173
    v_lshlrev_b32 v236, 16, v174
    v_and_b32 v237, 0xffff0000, v174
    v_lshlrev_b32 v238, 16, v175
    v_and_b32 v239, 0xffff0000, v175
    s_waitcnt vmcnt(10)
    v_xor_b32 v64, s101, v64
    v_xor_b32 v67, s101, v67
    v_xor_b32 v68, s101, v68
    v_xor_b32 v71, s101, v71
    v_xor_b32 v72, s101, v72
    v_xor_b32 v75, s101, v75
    v_xor_b32 v76, s101, v76
    v_xor_b32 v79, s101, v79
    v_xor_b32 v80, s101, v80
    v_xor_b32 v83, s101, v83
    v_xor_b32 v84, s101, v84
    v_xor_b32 v87, s101, v87
    v_xor_b32 v88, s101, v88
    v_xor_b32 v91, s101, v91
    v_xor_b32 v92, s101, v92
    v_xor_b32 v95, s101, v95
    v_xor_b32 v96, s101, v96
    v_xor_b32 v99, s101, v99
    v_xor_b32 v100, s101, v100
    v_xor_b32 v103, s101, v103
    v_xor_b32 v104, s101, v104
    v_xor_b32 v107, s101, v107
    v_xor_b32 v108, s101, v108
    v_xor_b32 v111, s101, v111
    v_xor_b32 v112, s101, v112
    v_xor_b32 v115, s101, v115
    v_xor_b32 v116, s101, v116
    v_xor_b32 v119, s101, v119
    v_xor_b32 v120, s101, v120
    v_xor_b32 v123, s101, v123
    v_xor_b32 v124, s101, v124
    v_xor_b32 v127, s101, v127
    v_or_b32 v10, v64, v67
    v_or_b32 v11, v68, v71
    v_or3_b32 v10, v10, v72, v75
    v_or3_b32 v11, v11, v76, v79
    v_or3_b32 v10, v10, v80, v83
    v_or3_b32 v11, v11, v84, v87
    v_or3_b32 v10, v10, v88, v91
    v_or3_b32 v11, v11, v92, v95
    v_or3_b32 v10, v10, v96, v99
    v_or3_b32 v11, v11, v100, v103
    v_or3_b32 v10, v10, v104, v107
    v_or3_b32 v11, v11, v108, v111
    v_or3_b32 v10, v10, v112, v115
    v_or3_b32 v11, v11, v116, v119
    v_or3_b32 v10, v10, v120, v123
    v_or3_b32 v11, v11, v124, v127
    v_or_b32 v10, v10, v11
    v_and_b32 v10, 0xc000c000, v10
    v_cmp_ne_u32 vcc, 0, v10
    s_cbranch_vccnz re_9
ok_10:
    s_waitcnt vmcnt(0)
    v_max3_u32 v10, v128, v129, v130
    v_max3_u32 v11, v131, v132, v133
    v_max3_u32 v11, v11, v134, v135
    v_max3_u32 v10, v10, v136, v137
    v_max3_u32 v11, v11, v138, v139
    v_max3_u32 v10, v10, v140, v141
    v_max3_u32 v11, v11, v142, v143
    v_max3_u32 v10, v10, v144, v145
    v_max3_u32 v11, v11, v146, v147
    v_max3_u32 v10, v10, v148, v149
    v_max3_u32 v11, v11, v150, v151
    v_max3_u32 v10, v10, v152, v153
    v_max3_u32 v11, v11, v154, v155
    v_max3_u32 v10, v10, v156, v157
    v_max3_u32 v11, v11, v158, v159
    v_max3_u32 v10, v10, v160, v161
    v_max3_u32 v11, v11, v162, v163
    v_max3_u32 v10, v10, v164, v165
    v_max3_u32 v11, v11, v166, v167
    v_max_u32 v10, v10, v11
    v_cmp_eq_u32 vcc, -1, v10
    s_cbranch_vccnz re_11
ok_12:
    v_mfma_f32_16x16x32_bf16 v[24:27], v[160:163], v[64:67], 0
    buffer_load_dwordx4 a[140:143], v2, s[32:35], s86 offen offset:3072 sc1
    v_mfma_f32_16x16x32_bf16 v[16:19], v[128:131], v[64:67], 0
    v_mfma_f32_16x16x32_bf16 v[28:31], v[160:163], v[68:71], 0
    v_mfma_f32_16x16x32_bf16 v[20:23], v[132:135], v[68:71], 0
    s_add_u32 s86, s86, 4096
    buffer_load_dwordx4 a[144:147], v2, s[32:35], s86 offen offset:0 sc1
    v_mfma_f32_16x16x32_bf16 v[40:43], v[160:163], v[72:75], 0
    v_mfma_f32_16x16x32_bf16 v[32:35], v[136:139], v[72:75], 0
    v_mfma_f32_16x16x32_bf16 v[44:47], v[160:163], v[76:79], 0
    buffer_load_dwordx4 a[148:151], v2, s[32:35], s86 offen offset:1024 sc1
    v_mfma_f32_16x16x32_bf16 v[36:39], v[140:143], v[76:79], 0
    v_add_f32 v10, 0x358637bd, v24
    v_add_f32 v12, 0x358637bd, v29
    v_rcp_f32 v10, v10
    v_rcp_f32 v12, v12
    v_mfma_f32_16x16x32_bf16 v[56:59], v[164:167], v[80:83], 0
    buffer_load_dwordx4 a[152:155], v2, s[32:35], s86 offen offset:2048 sc1
    v_mfma_f32_16x16x32_bf16 v[48:51], v[144:147], v[80:83], 0
    v_mfma_f32_16x16x32_bf16 v[60:63], v[164:167], v[84:87], 0
    v_mfma_f32_16x16x32_bf16 v[52:55], v[148:151], v[84:87], 0
    buffer_load_dwordx4 a[156:159], v2, s[32:35], s86 offen offset:3072 sc1
    v_mul_f32 v16, v16, v10
    v_mul_f32 v17, v17, v10
    v_mul_f32 v18, v18, v10
    v_mul_f32 v19, v19, v10
    v_mul_f32 v20, v20, v12
    v_mul_f32 v21, v21, v12
    v_mul_f32 v22, v22, v12
    v_mul_f32 v23, v23, v12
    v_cvt_pk_bf16_f32 v16, v16, v17
    v_cvt_pk_bf16_f32 v17, v18, v19
    s_add_u32 s86, s86, 4096
    buffer_load_dwordx4 a[160:163], v2, s[32:35], s86 offen offset:0 sc1
    v_cvt_pk_bf16_f32 v18, v20, v21
    v_cvt_pk_bf16_f32 v19, v22, v23
    ds_write_b128 v13, v[16:19] offset:0
    buffer_load_dwordx4 a[164:167], v2, s[32:35], s86 offen offset:1024 sc1
    v_add_f32 v10, 0x358637bd, v42
    v_add_f32 v12, 0x358637bd, v47
    v_rcp_f32 v10, v10
    v_rcp_f32 v12, v12
    v_mfma_f32_16x16x32_bf16 v[24:27], v[164:167], v[88:91], 0
    v_mfma_f32_16x16x32_bf16 v[16:19], v[152:155], v[88:91], 0
    buffer_load_dwordx4 a[168:171], v2, s[32:35], s86 offen offset:2048 sc1
    v_mfma_f32_16x16x32_bf16 v[28:31], v[164:167], v[92:95], 0
    v_mfma_f32_16x16x32_bf16 v[20:23], v[156:159], v[92:95], 0
    v_mul_f32 v32, v32, v10
    v_mul_f32 v33, v33, v10
    v_mul_f32 v34, v34, v10
    v_mul_f32 v35, v35, v10
    buffer_load_dwordx4 a[172:175], v2, s[32:35], s86 offen offset:3072 sc1
    v_mul_f32 v36, v36, v12
    v_mul_f32 v37, v37, v12
    v_mul_f32 v38, v38, v12
    v_mul_f32 v39, v39, v12
    v_cvt_pk_bf16_f32 v32, v32, v33
    v_cvt_pk_bf16_f32 v33, v34, v35
    v_cvt_pk_bf16_f32 v34, v36, v37
    v_cvt_pk_bf16_f32 v35, v38, v39
    ds_write_b128 v13, v[32:35] offset:2048
    s_add_u32 s86, s86, 4096
    buffer_load_dwordx4 a[176:179], v2, s[32:35], s86 offen offset:0 sc1
    v_add_f32 v10, 0x358637bd, v56
    v_add_f32 v12, 0x358637bd, v61
    v_rcp_f32 v10, v10
    v_rcp_f32 v12, v12
    v_mfma_f32_16x16x32_bf16 v[40:43], v[160:163], v[96:99], 0
    v_mfma_f32_16x16x32_bf16 v[32:35], v[128:131], v[96:99], 0
    buffer_load_dwordx4 a[180:183], v2, s[32:35], s86 offen offset:1024 sc1
    v_mfma_f32_16x16x32_bf16 v[44:47], v[160:163], v[100:103], 0
    v_mfma_f32_16x16x32_bf16 v[36:39], v[132:135], v[100:103], 0
    v_mul_f32 v48, v48, v10
    v_mul_f32 v49, v49, v10
    v_mul_f32 v50, v50, v10
    v_mul_f32 v51, v51, v10
    buffer_load_dwordx4 a[184:187], v2, s[32:35], s86 offen offset:2048 sc1
    v_mul_f32 v52, v52, v12
    v_mul_f32 v53, v53, v12
    v_mul_f32 v54, v54, v12
    v_mul_f32 v55, v55, v12
    v_cvt_pk_bf16_f32 v48, v48, v49
    v_cvt_pk_bf16_f32 v49, v50, v51
    v_cvt_pk_bf16_f32 v50, v52, v53
    v_cvt_pk_bf16_f32 v51, v54, v55
    ds_write_b128 v13, v[48:51] offset:4096
    buffer_load_dwordx4 a[188:191], v2, s[32:35], s86 offen offset:3072 sc1
    v_add_f32 v10, 0x358637bd, v26
    v_add_f32 v12, 0x358637bd, v31
    v_rcp_f32 v10, v10
    v_rcp_f32 v12, v12
    v_mfma_f32_16x16x32_bf16 v[56:59], v[160:163], v[104:107], 0
    v_mfma_f32_16x16x32_bf16 v[48:51], v[136:139], v[104:107], 0
    s_add_u32 s86, s86, 4096
    buffer_load_dwordx4 a[192:195], v2, s[32:35], s86 offen offset:0 sc1
    v_mfma_f32_16x16x32_bf16 v[60:63], v[160:163], v[108:111], 0
    v_mfma_f32_16x16x32_bf16 v[52:55], v[140:143], v[108:111], 0
    v_mul_f32 v16, v16, v10
    v_mul_f32 v17, v17, v10
    v_mul_f32 v18, v18, v10
    v_mul_f32 v19, v19, v10
    buffer_load_dwordx4 a[196:199], v2, s[32:35], s86 offen offset:1024 sc1
    v_mul_f32 v20, v20, v12
    v_mul_f32 v21, v21, v12
    v_mul_f32 v22, v22, v12
    v_mul_f32 v23, v23, v12
    v_cvt_pk_bf16_f32 v16, v16, v17
    v_cvt_pk_bf16_f32 v17, v18, v19
    v_cvt_pk_bf16_f32 v18, v20, v21
    v_cvt_pk_bf16_f32 v19, v22, v23
    ds_write_b128 v13, v[16:19] offset:6144
    buffer_load_dwordx4 a[200:203], v2, s[32:35], s86 offen offset:2048 sc1
    v_add_f32 v10, 0x358637bd, v40
    v_add_f32 v12, 0x358637bd, v45
    v_rcp_f32 v10, v10
    v_rcp_f32 v12, v12
    v_mfma_f32_16x16x32_bf16 v[24:27], v[164:167], v[112:115], 0
    v_mfma_f32_16x16x32_bf16 v[16:19], v[144:147], v[112:115], 0
    buffer_load_dwordx4 a[204:207], v2, s[32:35], s86 offen offset:3072 sc1
    v_mfma_f32_16x16x32_bf16 v[28:31], v[164:167], v[116:119], 0
    v_mfma_f32_16x16x32_bf16 v[20:23], v[148:151], v[116:119], 0
    v_mul_f32 v32, v32, v10
    v_mul_f32 v33, v33, v10
    v_mul_f32 v34, v34, v10
    v_mul_f32 v35, v35, v10
    s_add_u32 s86, s86, 4096
    buffer_load_dwordx4 a[208:211], v2, s[32:35], s86 offen offset:0 sc1
    v_mul_f32 v36, v36, v12
    v_mul_f32 v37, v37, v12
    v_mul_f32 v38, v38, v12
    v_mul_f32 v39, v39, v12
    v_cvt_pk_bf16_f32 v32, v32, v33
    v_cvt_pk_bf16_f32 v33, v34, v35
    v_cvt_pk_bf16_f32 v34, v36, v37
    v_cvt_pk_bf16_f32 v35, v38, v39
    ds_write_b128 v13, v[32:35] offset:256
    buffer_load_dwordx4 a[212:215], v2, s[32:35], s86 offen offset:1024 sc1
    v_add_f32 v10, 0x358637bd, v58
    v_add_f32 v12, 0x358637bd, v63
    v_rcp_f32 v10, v10
    v_rcp_f32 v12, v12
    v_mfma_f32_16x16x32_bf16 v[40:43], v[164:167], v[120:123], 0
    v_mfma_f32_16x16x32_bf16 v[32:35], v[152:155], v[120:123], 0
    buffer_load_dwordx4 a[216:219], v2, s[32:35], s86 offen offset:2048 sc1
    v_mfma_f32_16x16x32_bf16 v[44:47], v[164:167], v[124:127], 0
    v_mfma_f32_16x16x32_bf16 v[36:39], v[156:159], v[124:127], 0
    v_mul_f32 v48, v48, v10
    v_mul_f32 v49, v49, v10
    v_mul_f32 v50, v50, v10
    v_mul_f32 v51, v51, v10
    buffer_load_dwordx4 a[220:223], v2, s[32:35], s86 offen offset:3072 sc1
    v_mul_f32 v52, v52, v12
    v_mul_f32 v53, v53, v12
    v_mul_f32 v54, v54, v12
    v_mul_f32 v55, v55, v12
    v_cvt_pk_bf16_f32 v48, v48, v49
    v_cvt_pk_bf16_f32 v49, v50, v51
    v_cvt_pk_bf16_f32 v50, v52, v53
    v_cvt_pk_bf16_f32 v51, v54, v55
    ds_write_b128 v13, v[48:51] offset:2304
    s_add_u32 s86, s86, 4096
    buffer_load_dwordx4 a[224:227], v2, s[32:35], s86 offen offset:0 sc1
    v_add_f32 v10, 0x358637bd, v24
    v_add_f32 v12, 0x358637bd, v29
    v_rcp_f32 v10, v10
    v_rcp_f32 v12, v12
    v_mul_f32 v16, v16, v10
    v_mul_f32 v17, v17, v10
    v_mul_f32 v18, v18, v10
    v_mul_f32 v19, v19, v10
    buffer_load_dwordx4 a[228:231], v2, s[32:35], s86 offen offset:1024 sc1
    v_mul_f32 v20, v20, v12
    v_mul_f32 v21, v21, v12
    v_mul_f32 v22, v22, v12
    v_mul_f32 v23, v23, v12
    v_cvt_pk_bf16_f32 v16, v16, v17
    v_cvt_pk_bf16_f32 v17, v18, v19
    v_cvt_pk_bf16_f32 v18, v20, v21
    v_cvt_pk_bf16_f32 v19, v22, v23
    ds_write_b128 v13, v[16:19] offset:4352
    buffer_load_dwordx4 a[232:235], v2, s[32:35], s86 offen offset:2048 sc1
    v_add_f32 v10, 0x358637bd, v42
    v_add_f32 v12, 0x358637bd, v47
    v_rcp_f32 v10, v10
    v_rcp_f32 v12, v12
    v_mul_f32 v32, v32, v10
    v_mul_f32 v33, v33, v10
    v_mul_f32 v34, v34, v10
    v_mul_f32 v35, v35, v10
    buffer_load_dwordx4 a[236:239], v2, s[32:35], s86 offen offset:3072 sc1
    v_mul_f32 v36, v36, v12
    v_mul_f32 v37, v37, v12
    v_mul_f32 v38, v38, v12
    v_mul_f32 v39, v39, v12
    v_cvt_pk_bf16_f32 v32, v32, v33
    v_cvt_pk_bf16_f32 v33, v34, v35
    v_cvt_pk_bf16_f32 v34, v36, v37
    v_cvt_pk_bf16_f32 v35, v38, v39
    ds_write_b128 v13, v[32:35] offset:6400
    s_add_u32 s86, s86, 4096
    buffer_load_dwordx4 a[240:243], v2, s[32:35], s86 offen offset:0 sc1
    s_waitcnt lgkmcnt(0)
    s_barrier
    ds_read_b128 v[16:19], v2 offset:0
    ds_read_b128 v[20:23], v2 offset:1024
    ds_read_b128 v[24:27], v2 offset:2048
    ds_read_b128 v[28:31], v2 offset:3072
    ds_read_b128 v[32:35], v2 offset:4096
    buffer_load_dwordx4 a[244:247], v2, s[32:35], s86 offen offset:1024 sc1
    ds_read_b128 v[36:39], v2 offset:5120
    ds_read_b128 v[40:43], v2 offset:6144
    s_waitcnt lgkmcnt(6)
    v_mfma_f32_32x32x16_bf16 v[240:255], a[128:131], v[16:19], 0
    s_branch S_4
T_4:
    s_branch L_back
S_4:
    ds_read_b128 v[44:47], v2 offset:7168
    s_waitcnt lgkmcnt(6)
    v_mfma_f32_32x32x16_bf16 v[240:255], a[132:135], v[20:23], v[240:255]
    buffer_load_dwordx4 a[248:251], v2, s[32:35], s86 offen offset:2048 sc1
    ds_read_b128 v[16:19], v2 offset:8192
    s_waitcnt lgkmcnt(6)
    v_mfma_f32_32x32x16_bf16 v[240:255], a[136:139], v[24:27], v[240:255]
    ds_read_b128 v[20:23], v2 offset:9216
    s_waitcnt vmcnt(27) lgkmcnt(6)
    v_mfma_f32_32x32x16_bf16 v[240:255], a[140:143], v[28:31], v[240:255]
    buffer_load_dwordx4 a[252:255], v2, s[32:35], s86 offen offset:3072 sc1
    ds_read_b128 v[24:27], v2 offset:10240
    s_waitcnt vmcnt(27) lgkmcnt(6)
    v_mfma_f32_32x32x16_bf16 v[240:255], a[144:147], v[32:35], v[240:255]
    ds_read_b128 v[28:31], v2 offset:11264
    s_waitcnt vmcnt(26) lgkmcnt(6)
    v_mfma_f32_32x32x16_bf16 v[240:255], a[148:151], v[36:39], v[240:255]
    s_add_u32 m0, s73, 0
    s_nop 0
    buffer_load_dwordx4 v2, s[32:35], s27 offen offset:0 sc1 lds
    ds_read_b128 v[32:35], v2 offset:12288
    s_waitcnt vmcnt(26) lgkmcnt(6)
    v_mfma_f32_32x32x16_bf16 v[240:255], a[152:155], v[40:43], v[240:255]
    ds_read_b128 v[36:39], v2 offset:13312
    s_waitcnt vmcnt(25) lgkmcnt(6)
    v_mfma_f32_32x32x16_bf16 v[240:255], a[156:159], v[44:47], v[240:255]
    buffer_load_dwordx4 v2, s[32:35], s27 offen offset:1024 sc1 lds
    ds_read_b128 v[40:43], v2 offset:14336
    s_waitcnt vmcnt(25) lgkmcnt(6)
    v_mfma_f32_32x32x16_bf16 v[240:255], a[160:163], v[16:19], v[240:255]
    ds_read_b128 v[44:47], v2 offset:15360
    s_waitcnt vmcnt(24) lgkmcnt(6)
    v_mfma_f32_32x32x16_bf16 v[240:255], a[164:167], v[20:23], v[240:255]
    buffer_load_dwordx4 v2, s[32:35], s27 offen offset:2048 sc1 lds
    ds_read_b128 v[16:19], v2 offset:16384
    s_waitcnt vmcnt(24) lgkmcnt(6)
    v_mfma_f32_32x32x16_bf16 v[240:255], a[168:171], v[24:27], v[240:255]
    ds_read_b128 v[20:23], v2 offset:17408
    s_waitcnt vmcnt(23) lgkmcnt(6)
    v_mfma_f32_32x32x16_bf16 v[240:255], a[172:175], v[28:31], v[240:255]
    buffer_load_dwordx4 v2, s[32:35], s27 offen offset:3072 sc1 lds
    ds_read_b128 v[24:27], v2 offset:18432
    s_waitcnt vmcnt(23) lgkmcnt(6)
    v_mfma_f32_32x32x16_bf16 v[240:255], a[176:179], v[32:35], v[240:255]
    ds_read_b128 v[28:31], v2 offset:19456
    s_waitcnt vmcnt(22) lgkmcnt(6)
    v_mfma_f32_32x32x16_bf16 v[240:255], a[180:183], v[36:39], v[240:255]
    s_add_u32 m0, s73, 4096
    s_add_u32 s27, s27, 4096
    buffer_load_dwordx4 v2, s[32:35], s27 offen offset:0 sc1 lds
    ds_read_b128 v[32:35], v2 offset:20480
    s_waitcnt vmcnt(22) lgkmcnt(6)
    v_mfma_f32_32x32x16_bf16 v[240:255], a[184:187], v[40:43], v[240:255]
    ds_read_b128 v[36:39], v2 offset:21504
    s_waitcnt vmcnt(21) lgkmcnt(6)
    v_mfma_f32_32x32x16_bf16 v[240:255], a[188:191], v[44:47], v[240:255]
    buffer_load_dwordx4 v2, s[32:35], s27 offen offset:1024 sc1 lds
    ds_read_b128 v[40:43], v2 offset:22528
    s_waitcnt vmcnt(21) lgkmcnt(6)
    v_mfma_f32_32x32x16_bf16 v[240:255], a[192:195], v[16:19], v[240:255]
    ds_read_b128 v[44:47], v2 offset:23552
    s_waitcnt vmcnt(20) lgkmcnt(6)
    v_mfma_f32_32x32x16_bf16 v[240:255], a[196:199], v[20:23], v[240:255]
    buffer_load_dwordx4 v2, s[32:35], s27 offen offset:2048 sc1 lds
    ds_read_b128 v[16:19], v2 offset:24576
    s_waitcnt vmcnt(20) lgkmcnt(6)
    v_mfma_f32_32x32x16_bf16 v[240:255], a[200:203], v[24:27], v[240:255]
    ds_read_b128 v[20:23], v2 offset:25600
    s_waitcnt vmcnt(19) lgkmcnt(6)
    v_mfma_f32_32x32x16_bf16 v[240:255], a[204:207], v[28:31], v[240:255]
    buffer_load_dwordx4 v2, s[32:35], s27 offen offset:3072 sc1 lds
    ds_read_b128 v[24:27], v2 offset:26624
    s_waitcnt vmcnt(19) lgkmcnt(6)
    v_mfma_f32_32x32x16_bf16 v[240:255], a[208:211], v[32:35], v[240:255]
    ds_read_b128 v[28:31], v2 offset:27648
    s_waitcnt vmcnt(18) lgkmcnt(6)
    v_mfma_f32_32x32x16_bf16 v[240:255], a[212:215], v[36:39], v[240:255]
    s_add_u32 m0, s73, 8192
    s_add_u32 s27, s27, 4096
    buffer_load_dwordx4 v2, s[32:35], s27 offen offset:0 sc1 lds
    ds_read_b128 v[32:35], v2 offset:28672
    s_waitcnt vmcnt(18) lgkmcnt(6)
    v_mfma_f32_32x32x16_bf16 v[240:255], a[216:219], v[40:43], v[240:255]
    ds_read_b128 v[36:39], v2 offset:29696
    s_waitcnt vmcnt(17) lgkmcnt(6)
    v_mfma_f32_32x32x16_bf16 v[240:255], a[220:223], v[44:47], v[240:255]
    buffer_load_dwordx4 v2, s[32:35], s27 offen offset:1024 sc1 lds
    ds_read_b128 v[40:43], v2 offset:30720
    s_waitcnt vmcnt(17) lgkmcnt(6)
    v_mfma_f32_32x32x16_bf16 v[240:255], a[224:227], v[16:19], v[240:255]
    ds_read_b128 v[44:47], v2 offset:31744
    s_waitcnt vmcnt(16) lgkmcnt(6)
    v_mfma_f32_32x32x16_bf16 v[240:255], a[228:231], v[20:23], v[240:255]
    buffer_load_dwordx4 v2, s[32:35], s27 offen offset:2048 sc1 lds
    s_waitcnt vmcnt(16) lgkmcnt(5)
    v_mfma_f32_32x32x16_bf16 v[240:255], a[232:235], v[24:27], v[240:255]
    s_waitcnt vmcnt(15) lgkmcnt(4)
    v_mfma_f32_32x32x16_bf16 v[240:255], a[236:239], v[28:31], v[240:255]
    buffer_load_dwordx4 v2, s[32:35], s27 offen offset:3072 sc1 lds
    s_waitcnt vmcnt(15) lgkmcnt(3)
    v_mfma_f32_32x32x16_bf16 v[240:255], a[240:243], v[32:35], v[240:255]
    s_waitcnt vmcnt(14) lgkmcnt(2)
    v_mfma_f32_32x32x16_bf16 v[240:255], a[244:247], v[36:39], v[240:255]
    s_add_u32 m0, s73, 12288
    s_add_u32 s27, s27, 4096
    buffer_load_dwordx4 v2, s[32:35], s27 offen offset:0 sc1 lds
    s_waitcnt vmcnt(14) lgkmcnt(1)
    v_mfma_f32_32x32x16_bf16 v[240:255], a[248:251], v[40:43], v[240:255]
    s_waitcnt vmcnt(13) lgkmcnt(0)
    v_mfma_f32_32x32x16_bf16 v[240:255], a[252:255], v[44:47], v[240:255]
    buffer_load_dwordx4 v2, s[32:35], s27 offen offset:1024 sc1 lds
    buffer_load_dwordx4 v2, s[32:35], s27 offen offset:2048 sc1 lds
    buffer_load_dwordx4 v2, s[32:35], s27 offen offset:3072 sc1 lds
    s_nop 8
    v_pk_fma_f32 v[224:225], v[240:241], v[192:193], v[224:225]
    v_pk_fma_f32 v[226:227], v[242:243], v[194:195], v[226:227]
    v_pk_fma_f32 v[228:229], v[244:245], v[196:197], v[228:229]
    v_pk_fma_f32 v[230:231], v[246:247], v[198:199], v[230:231]
    v_pk_fma_f32 v[232:233], v[248:249], v[200:201], v[232:233]
    v_pk_fma_f32 v[234:235], v[250:251], v[202:203], v[234:235]
    v_pk_fma_f32 v[236:237], v[252:253], v[204:205], v[236:237]
    v_pk_fma_f32 v[238:239], v[254:255], v[206:207], v[238:239]
    v_cvt_pk_bf16_f32 v192, v224, v225
    v_cvt_pk_bf16_f32 v193, v226, v227
    v_cvt_pk_bf16_f32 v194, v228, v229
    v_cvt_pk_bf16_f32 v195, v230, v231
    v_cvt_pk_bf16_f32 v196, v232, v233
    v_cvt_pk_bf16_f32 v197, v234, v235
    v_cvt_pk_bf16_f32 v198, v236, v237
    v_cvt_pk_bf16_f32 v199, v238, v239
    v_lshlrev_b32 v224, 16, v192
    v_and_b32 v225, 0xffff0000, v192
    v_lshlrev_b32 v226, 16, v193
    v_and_b32 v227, 0xffff0000, v193
    v_lshlrev_b32 v228, 16, v194
    v_and_b32 v229, 0xffff0000, v194
    v_lshlrev_b32 v230, 16, v195
    v_and_b32 v231, 0xffff0000, v195
    v_pk_mul_f32 v[208:209], v[208:209], v[224:225]
    v_pk_mul_f32 v[210:211], v[210:211], v[226:227]
    v_pk_mul_f32 v[212:213], v[212:213], v[228:229]
    v_pk_mul_f32 v[214:215], v[214:215], v[230:231]
    v_cvt_pk_bf16_f32 v200, v208, v209
    v_cvt_pk_bf16_f32 v201, v210, v211
    v_cvt_pk_bf16_f32 v202, v212, v213
    v_cvt_pk_bf16_f32 v203, v214, v215
    buffer_store_dwordx4 v[200:203], v2, s[32:35], s83 offen offset:0 sc1
    v_lshlrev_b32 v232, 16, v196
    v_and_b32 v233, 0xffff0000, v196
    v_lshlrev_b32 v234, 16, v197
    v_and_b32 v235, 0xffff0000, v197
    v_lshlrev_b32 v236, 16, v198
    v_and_b32 v237, 0xffff0000, v198
    v_lshlrev_b32 v238, 16, v199
    v_and_b32 v239, 0xffff0000, v199
    v_pk_mul_f32 v[216:217], v[216:217], v[232:233]
    v_pk_mul_f32 v[218:219], v[218:219], v[234:235]
    v_pk_mul_f32 v[220:221], v[220:221], v[236:237]
    v_pk_mul_f32 v[222:223], v[222:223], v[238:239]
    v_cvt_pk_bf16_f32 v204, v216, v217
    v_cvt_pk_bf16_f32 v205, v218, v219
    v_cvt_pk_bf16_f32 v206, v220, v221
    v_cvt_pk_bf16_f32 v207, v222, v223
    buffer_store_dwordx4 v[204:207], v2, s[32:35], s83 offen offset:1024 sc1
    v_pk_add_f32 v[56:57], v[224:225], v[226:227]
    v_pk_mul_f32 v[58:59], v[224:225], v[224:225]
    v_pk_mul_f32 v[60:61], v[226:227], v[226:227]
    v_pk_add_f32 v[56:57], v[56:57], v[228:229]
    v_pk_fma_f32 v[58:59], v[228:229], v[228:229], v[58:59]
    v_pk_add_f32 v[56:57], v[56:57], v[230:231]
    v_pk_fma_f32 v[60:61], v[230:231], v[230:231], v[60:61]
    v_pk_add_f32 v[56:57], v[56:57], v[232:233]
    v_pk_fma_f32 v[58:59], v[232:233], v[232:233], v[58:59]
    v_pk_add_f32 v[56:57], v[56:57], v[234:235]
    v_pk_fma_f32 v[60:61], v[234:235], v[234:235], v[60:61]
    v_pk_add_f32 v[56:57], v[56:57], v[236:237]
    v_pk_fma_f32 v[58:59], v[236:237], v[236:237], v[58:59]
    v_pk_add_f32 v[56:57], v[56:57], v[238:239]
    v_pk_fma_f32 v[60:61], v[238:239], v[238:239], v[60:61]
    v_pk_add_f32 v[58:59], v[58:59], v[60:61]
    v_add_f32 v56, v56, v57
    v_add_f32 v57, v58, v59
    v_mov_b32 v58, v56
    v_mov_b32 v59, v57
    s_nop 0
    v_permlane32_swap_b32 v56, v58
    v_permlane32_swap_b32 v57, v59
    v_pk_add_f32 v[56:57], v[56:57], v[58:59]
    v_bfi_b32 v56, 63, s100, v56
    v_bfi_b32 v57, 63, s100, v57
    s_mov_b32 exec_hi, 0
    buffer_store_dwordx2 v[56:57], v3, s[32:35], s17 offen sc1
    s_mov_b32 exec_hi, -1
    v_mov_b32 v32, v184
    v_mov_b32 v33, v185
    v_mov_b32 v34, v186
    v_mov_b32 v35, v187
    s_waitcnt vmcnt(3)
    s_barrier
    ds_read_b128 a[128:131], v5 offset:0
    ds_read_b128 a[132:135], v5 offset:1024
    ds_read_b128 a[136:139], v5 offset:2048
    ds_read_b128 a[140:143], v5 offset:3072
    ds_read_b128 a[144:147], v5 offset:4096
    ds_read_b128 a[148:151], v5 offset:5120
    ds_read_b128 v[224:227], v9 offset:0
    ds_read_b128 v[228:231], v9 offset:32
    ds_read_b128 v[232:235], v9 offset:64
    ds_read_b128 v[236:239], v9 offset:96
    ds_read_b128 v[240:243], v9 offset:128
    ds_read_b128 v[244:247], v9 offset:160
    ds_read_b128 v[248:251], v9 offset:192
    ds_read_b128 a[152:155], v5 offset:6144
    s_waitcnt lgkmcnt(7)
    v_mfma_f32_16x16x32_bf16 v[48:51], v[224:227], a[128:131], 0
    buffer_load_dwordx4 v[64:67], v2, s[32:35], s20 offen offset:0 sc1
    ds_read_b128 v[252:255], v9 offset:224
    ds_read_b128 a[156:159], v5 offset:7168
    s_waitcnt lgkmcnt(8)
    v_mfma_f32_16x16x32_bf16 v[52:55], v[228:231], a[132:135], 0
    ds_read_b128 v[224:227], v9 offset:256
    ds_read_b128 a[160:163], v5 offset:8192
    s_waitcnt lgkmcnt(9)
    v_mfma_f32_16x16x32_bf16 v[48:51], v[232:235], a[136:139], v[48:51]
    buffer_load_dwordx4 v[68:71], v2, s[32:35], s21 offen offset:0 sc1
    ds_read_b128 v[228:231], v9 offset:288
    ds_read_b128 a[164:167], v5 offset:9216
    s_waitcnt lgkmcnt(10)
    v_mfma_f32_16x16x32_bf16 v[52:55], v[236:239], a[140:143], v[52:55]
    ds_read_b128 v[232:235], v9 offset:320
    ds_read_b128 a[168:171], v5 offset:10240
    s_waitcnt lgkmcnt(11)
    v_mfma_f32_16x16x32_bf16 v[48:51], v[240:243], a[144:147], v[48:51]
    buffer_load_dwordx4 v[72:75], v2, s[32:35], s20 offen offset:1024 sc1
    ds_read_b128 v[236:239], v9 offset:352
    ds_read_b128 a[172:175], v5 offset:11264
    s_waitcnt lgkmcnt(12)
    v_mfma_f32_16x16x32_bf16 v[52:55], v[244:247], a[148:151], v[52:55]
    ds_read_b128 v[240:243], v9 offset:384
    ds_read_b128 a[176:179], v5 offset:12288
    s_waitcnt lgkmcnt(12)
    v_mfma_f32_16x16x32_bf16 v[48:51], v[248:251], a[152:155], v[48:51]
    buffer_load_dwordx4 v[76:79], v2, s[32:35], s21 offen offset:1024 sc1
    ds_read_b128 v[244:247], v9 offset:416
    ds_read_b128 a[180:183], v5 offset:13312
    s_waitcnt lgkmcnt(12)
    v_mfma_f32_16x16x32_bf16 v[52:55], v[252:255], a[156:159], v[52:55]
    ds_read_b128 v[248:251], v9 offset:448
    ds_read_b128 a[184:187], v5 offset:14336
    s_waitcnt lgkmcnt(12)
    v_mfma_f32_16x16x32_bf16 v[48:51], v[224:227], a[160:163], v[48:51]
    buffer_load_dwordx4 v[80:83], v2, s[32:35], s20 offen offset:2048 sc1
    ds_read_b128 v[252:255], v9 offset:480
    ds_read_b128 a[188:191], v5 offset:15360
    s_waitcnt lgkmcnt(12)
    v_mfma_f32_16x16x32_bf16 v[52:55], v[228:231], a[164:167], v[52:55]
    ds_read_b128 v[224:227], v9 offset:512
    ds_read_b128 a[192:195], v5 offset:16384
    s_waitcnt lgkmcnt(12)
    v_mfma_f32_16x16x32_bf16 v[48:51], v[232:235], a[168:171], v[48:51]
    buffer_load_dwordx4 v[84:87], v2, s[32:35], s21 offen offset:2048 sc1
    ds_read_b128 v[228:231], v9 offset:544
    ds_read_b128 a[196:199], v5 offset:17408
    s_waitcnt lgkmcnt(12)
    v_mfma_f32_16x16x32_bf16 v[52:55], v[236:239], a[172:175], v[52:55]
    ds_read_b128 v[232:235], v9 offset:576
    ds_read_b128 a[200:203], v5 offset:18432
    s_waitcnt lgkmcnt(12)
    v_mfma_f32_16x16x32_bf16 v[48:51], v[240:243], a[176:179], v[48:51]
    s_add_u32 s91, s18, 0
    s_add_u32 m0, s55, 0
    s_nop 0
    buffer_load_dwordx4 v2, s[32:35], s91 offen offset:0 sc1 lds
    ds_read_b128 v[236:239], v9 offset:608
    ds_read_b128 a[204:207], v5 offset:19456
    s_waitcnt lgkmcnt(12)
    v_mfma_f32_16x16x32_bf16 v[52:55], v[244:247], a[180:183], v[52:55]
    ds_read_b128 v[240:243], v9 offset:640
    ds_read_b128 a[208:211], v5 offset:20480
    s_waitcnt lgkmcnt(12)
    v_mfma_f32_16x16x32_bf16 v[48:51], v[248:251], a[184:187], v[48:51]
    buffer_load_dwordx4 v2, s[32:35], s91 offen offset:1024 sc1 lds
    ds_read_b128 v[244:247], v9 offset:672
    ds_read_b128 a[212:215], v5 offset:21504
    s_waitcnt lgkmcnt(12)
    v_mfma_f32_16x16x32_bf16 v[52:55], v[252:255], a[188:191], v[52:55]
    ds_read_b128 v[248:251], v9 offset:704
    ds_read_b128 a[216:219], v5 offset:22528
    s_waitcnt lgkmcnt(12)
    v_mfma_f32_16x16x32_bf16 v[48:51], v[224:227], a[192:195], v[48:51]
    buffer_load_dwordx4 v2, s[32:35], s91 offen offset:2048 sc1 lds
    ds_read_b128 v[252:255], v9 offset:736
    ds_read_b128 a[220:223], v5 offset:23552
    s_waitcnt lgkmcnt(12)
    v_mfma_f32_16x16x32_bf16 v[52:55], v[228:231], a[196:199], v[52:55]
    ds_read_b128 v[224:227], v9 offset:768
    ds_read_b128 a[224:227], v5 offset:24576
    s_waitcnt lgkmcnt(12)
    v_mfma_f32_16x16x32_bf16 v[48:51], v[232:235], a[200:203], v[48:51]
    buffer_load_dwordx4 v2, s[32:35], s91 offen offset:3072 sc1 lds
    ds_read_b128 v[228:231], v9 offset:800
    ds_read_b128 a[228:231], v5 offset:25600
    s_waitcnt lgkmcnt(12)
    v_mfma_f32_16x16x32_bf16 v[52:55], v[236:239], a[204:207], v[52:55]
    ds_read_b128 v[232:235], v9 offset:832
    ds_read_b128 a[232:235], v5 offset:26624
    s_waitcnt lgkmcnt(12)
    v_mfma_f32_16x16x32_bf16 v[48:51], v[240:243], a[208:211], v[48:51]
    s_add_u32 s91, s18, 65536
    s_add_u32 m0, s55, 65536
    s_nop 0
    buffer_load_dwordx4 v2, s[32:35], s91 offen offset:0 sc1 lds
    ds_read_b128 v[236:239], v9 offset:864
    ds_read_b128 a[236:239], v5 offset:27648
    s_waitcnt lgkmcnt(12)
    v_mfma_f32_16x16x32_bf16 v[52:55], v[244:247], a[212:215], v[52:55]
    ds_read_b128 v[240:243], v9 offset:896
    ds_read_b128 a[240:243], v5 offset:28672
    s_waitcnt lgkmcnt(12)
    v_mfma_f32_16x16x32_bf16 v[48:51], v[248:251], a[216:219], v[48:51]
    buffer_load_dwordx4 v2, s[32:35], s91 offen offset:1024 sc1 lds
    ds_read_b128 v[244:247], v9 offset:928
    ds_read_b128 a[244:247], v5 offset:29696
    s_waitcnt lgkmcnt(12)
    v_mfma_f32_16x16x32_bf16 v[52:55], v[252:255], a[220:223], v[52:55]
    ds_read_b128 v[248:251], v9 offset:960
    ds_read_b128 a[248:251], v5 offset:30720
    s_waitcnt lgkmcnt(12)
    v_mfma_f32_16x16x32_bf16 v[48:51], v[224:227], a[224:227], v[48:51]
    buffer_load_dwordx4 v2, s[32:35], s91 offen offset:2048 sc1 lds
    ds_read_b128 v[252:255], v9 offset:992
    ds_read_b128 a[252:255], v5 offset:31744
    s_waitcnt lgkmcnt(12)
    v_mfma_f32_16x16x32_bf16 v[52:55], v[228:231], a[228:231], v[52:55]
    s_waitcnt lgkmcnt(10)
    v_mfma_f32_16x16x32_bf16 v[48:51], v[232:235], a[232:235], v[48:51]
    s_waitcnt lgkmcnt(8)
    v_mfma_f32_16x16x32_bf16 v[52:55], v[236:239], a[236:239], v[52:55]
    buffer_load_dwordx4 v2, s[32:35], s91 offen offset:3072 sc1 lds
    s_waitcnt lgkmcnt(6)
    v_mfma_f32_16x16x32_bf16 v[48:51], v[240:243], a[240:243], v[48:51]
    s_waitcnt lgkmcnt(4)
    v_mfma_f32_16x16x32_bf16 v[52:55], v[244:247], a[244:247], v[52:55]
    s_waitcnt lgkmcnt(2)
    v_mfma_f32_16x16x32_bf16 v[48:51], v[248:251], a[248:251], v[48:51]
    s_waitcnt lgkmcnt(0)
    v_mfma_f32_16x16x32_bf16 v[52:55], v[252:255], a[252:255], v[52:55]
    s_add_u32 s91, s18, 16384
    s_add_u32 m0, s55, 16384
    s_nop 0
    buffer_load_dwordx4 v2, s[32:35], s91 offen offset:0 sc1 lds
    s_lshl_b32 s60, s71, 16
    v_add_u32 v6, s60, v2
    v_xor_b32 v7, 0x10000, v6
    v_and_b32 v5, 0xf8, v3
    v_lshrrev_b32 v9, 5, v1
    v_lshl_add_u32 v9, v9, 11, v5
    v_add_u32 v62, 0x10000, v4
    v_add_f32 v48, v48, v52
    v_add_f32 v49, v49, v53
    v_cvt_pk_bf16_f32 v36, v48, v49
    v_lshlrev_b32 v38, 16, v36
    v_and_b32 v39, 0xffff0000, v36
    v_sub_f32 v48, v48, v38
    v_sub_f32 v49, v49, v39
    v_mov_b32 v37, v36
    v_cvt_pk_bf16_f32 v38, v48, v49
    v_cvt_pk_bf16_f32 v39, v48, v49
    buffer_load_dwordx4 v2, s[32:35], s91 offen offset:1024 sc1 lds
    buffer_load_dwordx4 v2, s[32:35], s91 offen offset:2048 sc1 lds
    buffer_load_dwordx4 v2, s[32:35], s91 offen offset:3072 sc1 lds
    s_add_u32 s91, s18, 81920
    s_add_u32 m0, s55, 81920
    s_nop 0
    buffer_load_dwordx4 v2, s[32:35], s91 offen offset:0 sc1 lds
    buffer_load_dwordx4 v2, s[32:35], s91 offen offset:1024 sc1 lds
    buffer_load_dwordx4 v2, s[32:35], s91 offen offset:2048 sc1 lds
    buffer_load_dwordx4 v2, s[32:35], s91 offen offset:3072 sc1 lds
    s_waitcnt vmcnt(12)
    ds_read2st64_b32 v[208:209], v4 offset0:0 offset1:4
    ds_read2st64_b32 v[210:211], v4 offset0:8 offset1:12
    s_waitcnt vmcnt(8)
    ds_read2st64_b32 v[212:213], v62 offset0:0 offset1:4
    ds_read2st64_b32 v[214:215], v62 offset0:8 offset1:12
    s_waitcnt lgkmcnt(0)
    v_max_u32 v60, v208, v209
    v_max3_u32 v60, v60, v210, v211
    v_max3_u32 v60, v60, v212, v213
    v_max3_u32 v60, v60, v214, v215
    v_cmp_eq_u32 vcc, -1, v60
    s_cbranch_vccnz re_13
ok_14:
    s_waitcnt lgkmcnt(0)
    s_barrier
    ds_read_b128 v[224:227], v6 offset:0
    buffer_load_dwordx2 v[40:41], v9, s[32:35], s19 offen offset:0 sc1
    ds_read_b128 v[228:231], v6 offset:1024
    ds_read_b128 v[232:235], v6 offset:2048
    buffer_load_dwordx2 v[42:43], v9, s[32:35], s19 offen offset:256 sc1
    ds_read_b128 v[236:239], v6 offset:3072
    ds_read_b128 v[240:243], v6 offset:4096
    buffer_load_dwordx2 v[44:45], v9, s[32:35], s19 offen offset:512 sc1
    s_waitcnt lgkmcnt(4)
    v_mfma_f32_32x32x16_bf16 v[128:143], a[0:3], v[224:227], 0
    buffer_load_dwordx2 v[46:47], v9, s[32:35], s19 offen offset:768 sc1
    ds_read_b128 v[244:247], v6 offset:5120
    v_mfma_f32_32x32x16_bf16 v[144:159], a[128:131], v[224:227], 0
    buffer_load_dwordx2 v[48:49], v9, s[32:35], s19 offen offset:1024 sc1
    s_waitcnt lgkmcnt(4)
    v_mfma_f32_32x32x16_bf16 v[128:143], a[4:7], v[228:231], v[128:143]
    buffer_load_dwordx2 v[50:51], v9, s[32:35], s19 offen offset:1280 sc1
    ds_read_b128 v[248:251], v6 offset:6144
    v_mfma_f32_32x32x16_bf16 v[144:159], a[132:135], v[228:231], v[144:159]
    buffer_load_dwordx2 v[52:53], v9, s[32:35], s19 offen offset:1536 sc1
    s_waitcnt lgkmcnt(4)
    v_mfma_f32_32x32x16_bf16 v[128:143], a[8:11], v[232:235], v[128:143]
    buffer_load_dwordx2 v[54:55], v9, s[32:35], s19 offen offset:1792 sc1
    ds_read_b128 v[252:255], v6 offset:7168
    v_mfma_f32_32x32x16_bf16 v[144:159], a[136:139], v[232:235], v[144:159]
    s_add_u32 s91, s18, 32768
    s_add_u32 m0, s55, 32768
    s_nop 0
    buffer_load_dwordx4 v2, s[32:35], s91 offen offset:0 sc1 lds
    s_waitcnt lgkmcnt(4)
    v_mfma_f32_32x32x16_bf16 v[128:143], a[12:15], v[236:239], v[128:143]
    ds_read_b128 v[224:227], v6 offset:8192
    v_mfma_f32_32x32x16_bf16 v[144:159], a[140:143], v[236:239], v[144:159]
    s_waitcnt lgkmcnt(4)
    v_mfma_f32_32x32x16_bf16 v[128:143], a[16:19], v[240:243], v[128:143]
    buffer_load_dwordx4 v2, s[32:35], s91 offen offset:1024 sc1 lds
    ds_read_b128 v[228:231], v6 offset:9216
    v_mfma_f32_32x32x16_bf16 v[144:159], a[144:147], v[240:243], v[144:159]
    s_waitcnt lgkmcnt(4)
    v_mfma_f32_32x32x16_bf16 v[128:143], a[20:23], v[244:247], v[128:143]
    buffer_load_dwordx4 v2, s[32:35], s91 offen offset:2048 sc1 lds
    ds_read_b128 v[232:235], v6 offset:10240
    s_waitcnt vmcnt(15)
    ds_read2st64_b32 v[208:209], v4 offset0:64 offset1:68
    ds_read2st64_b32 v[210:211], v4 offset0:72 offset1:76
    s_waitcnt vmcnt(11)
    ds_read2st64_b32 v[212:213], v62 offset0:64 offset1:68
    ds_read2st64_b32 v[214:215], v62 offset0:72 offset1:76
    v_mfma_f32_32x32x16_bf16 v[144:159], a[148:151], v[244:247], v[144:159]
    s_waitcnt lgkmcnt(8)
    v_mfma_f32_32x32x16_bf16 v[128:143], a[24:27], v[248:251], v[128:143]
    buffer_load_dwordx4 v2, s[32:35], s91 offen offset:3072 sc1 lds
    ds_read_b128 v[236:239], v6 offset:11264
    s_waitcnt lgkmcnt(1)
    v_max_u32 v60, v208, v209
    v_max3_u32 v60, v60, v210, v211
    v_max3_u32 v60, v60, v212, v213
    v_max3_u32 v60, v60, v214, v215
    v_mfma_f32_32x32x16_bf16 v[144:159], a[152:155], v[248:251], v[144:159]
    v_cmp_eq_u32 vcc, -1, v60
    s_cbranch_vccnz re_15
ok_16:
    v_mfma_f32_32x32x16_bf16 v[128:143], a[28:31], v[252:255], v[128:143]
    s_add_u32 s91, s18, 98304
    s_add_u32 m0, s55, 98304
    s_nop 0
    buffer_load_dwordx4 v2, s[32:35], s91 offen offset:0 sc1 lds
    ds_read_b128 v[240:243], v6 offset:12288
    v_mfma_f32_32x32x16_bf16 v[144:159], a[156:159], v[252:255], v[144:159]
    v_mfma_f32_32x32x16_bf16 v[128:143], a[32:35], v[224:227], v[128:143]
    ds_read_b128 v[244:247], v6 offset:13312
    buffer_load_dwordx4 v2, s[32:35], s91 offen offset:1024 sc1 lds
    v_mfma_f32_32x32x16_bf16 v[144:159], a[160:163], v[224:227], v[144:159]
    v_mfma_f32_32x32x16_bf16 v[128:143], a[36:39], v[228:231], v[128:143]
    ds_read_b128 v[248:251], v6 offset:14336
    buffer_load_dwordx4 v2, s[32:35], s91 offen offset:2048 sc1 lds
    v_mfma_f32_32x32x16_bf16 v[144:159], a[164:167], v[228:231], v[144:159]
    v_mfma_f32_32x32x16_bf16 v[128:143], a[40:43], v[232:235], v[128:143]
    ds_read_b128 v[252:255], v6 offset:15360
    buffer_load_dwordx4 v2, s[32:35], s91 offen offset:3072 sc1 lds
    v_mfma_f32_32x32x16_bf16 v[144:159], a[168:171], v[232:235], v[144:159]
    s_barrier
    s_waitcnt lgkmcnt(4)
    v_mfma_f32_32x32x16_bf16 v[128:143], a[44:47], v[236:239], v[128:143]
    ds_read_b128 v[224:227], v6 offset:16384
    s_add_u32 s91, s18, 49152
    s_add_u32 m0, s55, 49152
    s_nop 0
    buffer_load_dwordx4 v2, s[32:35], s91 offen offset:0 sc1 lds
    v_mfma_f32_32x32x16_bf16 v[144:159], a[172:175], v[236:239], v[144:159]
    s_waitcnt lgkmcnt(4)
    v_mfma_f32_32x32x16_bf16 v[128:143], a[48:51], v[240:243], v[128:143]
    ds_read_b128 v[228:231], v6 offset:17408
    s_waitcnt vmcnt(9)
    v_xor_b32 v60, s100, v40
    buffer_load_dwordx4 v2, s[32:35], s91 offen offset:1024 sc1 lds
    v_bitop3_b32 v60, v41, s100, v60 bitop3:0xbe
    v_bitop3_b32 v60, v42, s100, v60 bitop3:0xbe
    v_bitop3_b32 v60, v43, s100, v60 bitop3:0xbe
    v_mfma_f32_32x32x16_bf16 v[144:159], a[176:179], v[240:243], v[144:159]
    v_bitop3_b32 v60, v44, s100, v60 bitop3:0xbe
    v_bitop3_b32 v60, v45, s100, v60 bitop3:0xbe
    v_bitop3_b32 v60, v46, s100, v60 bitop3:0xbe
    v_bitop3_b32 v60, v47, s100, v60 bitop3:0xbe
    v_bitop3_b32 v60, v48, s100, v60 bitop3:0xbe
    s_waitcnt lgkmcnt(4)
    v_mfma_f32_32x32x16_bf16 v[128:143], a[52:55], v[244:247], v[128:143]
    buffer_load_dwordx4 v2, s[32:35], s91 offen offset:2048 sc1 lds
    ds_read_b128 v[232:235], v6 offset:18432
    v_bitop3_b32 v60, v49, s100, v60 bitop3:0xbe
    v_bitop3_b32 v60, v50, s100, v60 bitop3:0xbe
    v_bitop3_b32 v60, v51, s100, v60 bitop3:0xbe
    v_bitop3_b32 v60, v52, s100, v60 bitop3:0xbe
    v_mfma_f32_32x32x16_bf16 v[144:159], a[180:183], v[244:247], v[144:159]
    v_bitop3_b32 v60, v53, s100, v60 bitop3:0xbe
    v_bitop3_b32 v60, v54, s100, v60 bitop3:0xbe
    v_bitop3_b32 v60, v55, s100, v60 bitop3:0xbe
    v_and_b32 v60, 63, v60
    v_cmp_ne_u32 vcc, 0, v60
    s_cbranch_vccnz re_17
ok_18:
    s_waitcnt lgkmcnt(4)
    v_mfma_f32_32x32x16_bf16 v[128:143], a[56:59], v[248:251], v[128:143]
    buffer_load_dwordx4 v2, s[32:35], s91 offen offset:3072 sc1 lds
    ds_read_b128 v[236:239], v6 offset:19456
    v_add_f32 v40, v40, v42
    v_add_f32 v41, v41, v43
    v_add_f32 v40, v40, v44
    v_add_f32 v41, v41, v45
    v_mfma_f32_32x32x16_bf16 v[144:159], a[184:187], v[248:251], v[144:159]
    v_add_f32 v40, v40, v46
    v_add_f32 v41, v41, v47
    v_add_f32 v40, v40, v48
    v_add_f32 v41, v41, v49
    v_add_f32 v40, v40, v50
    s_add_u32 s91, s18, 114688
    s_add_u32 m0, s55, 114688
    s_nop 0
    buffer_load_dwordx4 v2, s[32:35], s91 offen offset:0 sc1 lds
    s_waitcnt lgkmcnt(4)
    v_mfma_f32_32x32x16_bf16 v[128:143], a[60:63], v[252:255], v[128:143]
    ds_read_b128 v[240:243], v6 offset:20480
    v_add_f32 v41, v41, v51
    v_add_f32 v40, v40, v52
    v_add_f32 v41, v41, v53
    v_add_f32 v40, v40, v54
    v_mfma_f32_32x32x16_bf16 v[144:159], a[188:191], v[252:255], v[144:159]
    v_add_f32 v41, v41, v55
    buffer_load_dwordx4 v2, s[32:35], s91 offen offset:1024 sc1 lds
    v_mov_b32 v42, v40
    v_mov_b32 v43, v41
    s_lshl_b32 s60, s3, 10
    s_add_u32 s60, s60, 131072
    s_waitcnt lgkmcnt(4)
    v_mfma_f32_32x32x16_bf16 v[128:143], a[64:67], v[224:227], v[128:143]
    ds_read_b128 v[244:247], v6 offset:21504
    v_permlane32_swap_b32 v40, v42
    v_permlane32_swap_b32 v41, v43
    v_lshlrev_b32 v5, 2, v5
    v_add_f32 v40, v40, v42
    buffer_load_dwordx4 v2, s[32:35], s91 offen offset:2048 sc1 lds
    v_mfma_f32_32x32x16_bf16 v[144:159], a[192:195], v[224:227], v[144:159]
    v_add_f32 v41, v41, v43
    v_mul_f32 v40, 0xbb000000, v40
    v_mov_b32 v42, 0x3727c5ac
    v_fmamk_f32 v41, v41, 0x3b000000, v42
    v_fma_f32 v41, -v40, v40, v41
    s_waitcnt lgkmcnt(4)
    v_mfma_f32_32x32x16_bf16 v[128:143], a[68:71], v[228:231], v[128:143]
    ds_read_b128 v[248:251], v6 offset:22528
    v_max_f32 v41, v41, v42
    buffer_load_dwordx4 v2, s[32:35], s91 offen offset:3072 sc1 lds
    v_rsq_f32 v48, v41
    v_add_u32 v9, s60, v5
    v_mfma_f32_32x32x16_bf16 v[144:159], a[196:199], v[228:231], v[144:159]
    v_mul_f32 v41, v41, v48
    v_mul_f32 v48, 0xbfb8aa3b, v48
    v_mov_b32 v49, v41
    v_cvt_pk_bf16_f32 v44, v40, v41
    v_lshlrev_b32 v45, 16, v44
    s_waitcnt lgkmcnt(4)
    v_mfma_f32_32x32x16_bf16 v[128:143], a[72:75], v[232:235], v[128:143]
    ds_read_b128 v[252:255], v6 offset:23552
    buffer_store_dwordx4 v[192:195], v2, s[32:35], s16 offen sc1
    v_and_b32 v47, 0xffff0000, v44
    v_sub_f32 v40, v40, v45
    v_sub_f32 v41, v41, v47
    v_mov_b32 v46, v44
    v_mfma_f32_32x32x16_bf16 v[144:159], a[200:203], v[232:235], v[144:159]
    v_cvt_pk_bf16_f32 v45, v40, v41
    v_cvt_pk_bf16_f32 v47, v40, v41
    ds_write_b128 v9, v[44:47]
    ds_write_b64 v9, v[48:49] offset:16
    s_lshl_b32 s60, s71, 11
    s_waitcnt lgkmcnt(6)
    v_mfma_f32_32x32x16_bf16 v[128:143], a[76:79], v[236:239], v[128:143]
    buffer_store_dwordx4 v[196:199], v2, s[32:35], s16 offen offset:1024 sc1
    ds_read_b128 v[224:227], v6 offset:24576
    s_add_u32 s60, s60, 131072
    v_add_u32 v5, s60, v5
    v_xor_b32 v61, 0x800, v5
    v_mfma_f32_32x32x16_bf16 v[144:159], a[204:207], v[236:239], v[144:159]
    s_waitcnt lgkmcnt(6)
    v_mfma_f32_32x32x16_bf16 v[128:143], a[80:83], v[240:243], v[128:143]
    s_branch S_5
T_5:
    s_branch L_back
S_5:
    ds_read_b128 v[228:231], v6 offset:25600
    v_mfma_f32_32x32x16_bf16 v[144:159], a[208:211], v[240:243], v[144:159]
    buffer_load_dwordx4 v[88:91], v2, s[32:35], s20 offen offset:3072 sc1
    s_waitcnt lgkmcnt(6)
    v_mfma_f32_32x32x16_bf16 v[128:143], a[84:87], v[244:247], v[128:143]
    ds_read_b128 v[232:235], v6 offset:26624
    v_mfma_f32_32x32x16_bf16 v[144:159], a[212:215], v[244:247], v[144:159]
    buffer_load_dwordx4 v[92:95], v2, s[32:35], s21 offen offset:3072 sc1
    s_waitcnt lgkmcnt(6)
    v_mfma_f32_32x32x16_bf16 v[128:143], a[88:91], v[248:251], v[128:143]
    ds_read_b128 v[236:239], v6 offset:27648
    v_mfma_f32_32x32x16_bf16 v[144:159], a[216:219], v[248:251], v[144:159]
    s_add_u32 s20, s20, 4096
    buffer_load_dwordx4 v[96:99], v2, s[32:35], s20 offen offset:0 sc1
    s_waitcnt lgkmcnt(6)
    v_mfma_f32_32x32x16_bf16 v[128:143], a[92:95], v[252:255], v[128:143]
    ds_read_b128 v[240:243], v6 offset:28672
    v_mfma_f32_32x32x16_bf16 v[144:159], a[220:223], v[252:255], v[144:159]
    s_waitcnt lgkmcnt(4)
    v_mfma_f32_32x32x16_bf16 v[128:143], a[96:99], v[224:227], v[128:143]
    s_add_u32 s21, s21, 4096
    buffer_load_dwordx4 v[100:103], v2, s[32:35], s21 offen offset:0 sc1
    ds_read_b128 v[244:247], v6 offset:29696
    s_waitcnt vmcnt(18)
    ds_read2st64_b32 v[208:209], v4 offset0:128 offset1:132
    ds_read2st64_b32 v[210:211], v4 offset0:136 offset1:140
    s_waitcnt vmcnt(14)
    ds_read2st64_b32 v[212:213], v62 offset0:128 offset1:132
    ds_read2st64_b32 v[214:215], v62 offset0:136 offset1:140
    v_mfma_f32_32x32x16_bf16 v[144:159], a[224:227], v[224:227], v[144:159]
    s_waitcnt lgkmcnt(8)
    v_mfma_f32_32x32x16_bf16 v[128:143], a[100:103], v[228:231], v[128:143]
    buffer_load_dwordx4 v[104:107], v2, s[32:35], s20 offen offset:1024 sc1
    ds_read_b128 v[248:251], v6 offset:30720
    s_waitcnt lgkmcnt(1)
    v_max_u32 v60, v208, v209
    v_max3_u32 v60, v60, v210, v211
    v_max3_u32 v60, v60, v212, v213
    v_max3_u32 v60, v60, v214, v215
    v_mfma_f32_32x32x16_bf16 v[144:159], a[228:231], v[228:231], v[144:159]
    v_cmp_eq_u32 vcc, -1, v60
    s_cbranch_vccnz re_19
ok_20:
    v_mfma_f32_32x32x16_bf16 v[128:143], a[104:107], v[232:235], v[128:143]
    buffer_load_dwordx4 v[108:111], v2, s[32:35], s21 offen offset:1024 sc1
    ds_read_b128 v[252:255], v6 offset:31744
    v_mfma_f32_32x32x16_bf16 v[144:159], a[232:235], v[232:235], v[144:159]
    s_waitcnt lgkmcnt(0)
    s_barrier
    v_mfma_f32_32x32x16_bf16 v[128:143], a[108:111], v[236:239], v[128:143]
    buffer_load_dwordx4 v[112:115], v2, s[32:35], s20 offen offset:2048 sc1
    ds_read_b128 v[224:227], v6 offset:32768
    ds_read_b128 v[16:19], v5 offset:0
    ds_read_b64 v[8:9], v5 offset:16
    ds_read_b128 v[20:23], v5 offset:1024
    ds_read_b64 v[10:11], v5 offset:1040
    v_mfma_f32_32x32x16_bf16 v[144:159], a[236:239], v[236:239], v[144:159]
    ds_read_b128 v[24:27], v61 offset:0
    ds_read_b64 v[12:13], v61 offset:16
    ds_read_b128 v[28:31], v61 offset:1024
    buffer_load_dwordx4 v[116:119], v2, s[32:35], s21 offen offset:2048 sc1
    ds_read_b64 v[14:15], v61 offset:1040
    v_mfma_f32_32x32x16_bf16 v[128:143], a[112:115], v[240:243], v[128:143]
    ds_read_b128 v[228:231], v6 offset:33792
    v_mfma_f32_32x32x16_bf16 v[144:159], a[240:243], v[240:243], v[144:159]
    v_mfma_f32_32x32x16_bf16 v[128:143], a[116:119], v[244:247], v[128:143]
    buffer_load_dwordx4 v[120:123], v2, s[32:35], s20 offen offset:3072 sc1
    ds_read_b128 v[232:235], v6 offset:34816
    v_mfma_f32_32x32x16_bf16 v[144:159], a[244:247], v[244:247], v[144:159]
    s_waitcnt lgkmcnt(12)
    v_mfma_f32_32x32x16_bf16 v[128:143], a[120:123], v[248:251], v[128:143]
    buffer_load_dwordx4 v[124:127], v2, s[32:35], s21 offen offset:3072 sc1
    ds_read_b128 v[236:239], v6 offset:35840
    v_mfma_f32_32x32x16_bf16 v[144:159], a[248:251], v[248:251], v[144:159]
    s_waitcnt lgkmcnt(12)
    v_mfma_f32_32x32x16_bf16 v[128:143], a[124:127], v[252:255], v[128:143]
    ds_read_b128 v[240:243], v6 offset:36864
    v_mfma_f32_32x32x16_bf16 v[144:159], a[252:255], v[252:255], v[144:159]
    s_waitcnt lgkmcnt(10)
    v_mfma_f32_32x32x16_bf16 v[128:143], v[32:35], v[16:19], v[128:143]
    v_mfma_f32_32x32x16_bf16 v[144:159], v[36:39], v[16:19], v[144:159]
    v_mfma_f32_32x32x16_bf16 v[160:175], a[0:3], v[224:227], 0
    ds_read_b128 v[244:247], v6 offset:37888
    v_mfma_f32_32x32x16_bf16 v[176:191], a[128:131], v[224:227], 0
    s_nop 7
    v_mul_f32 v128, v128, v8
    v_mul_f32 v129, v129, v8
    v_exp_f32 v128, v128
    v_mul_f32 v130, v130, v8
    s_waitcnt lgkmcnt(4)
    v_mfma_f32_32x32x16_bf16 v[160:175], a[4:7], v[228:231], v[160:175]
    s_add_u32 s20, s20, 4096
    buffer_load_dwordx4 a[128:131], v2, s[32:35], s20 offen offset:0 sc1
    ds_read_b128 v[248:251], v6 offset:38912
    v_exp_f32 v129, v129
    v_mul_f32 v131, v131, v8
    v_exp_f32 v130, v130
    v_mfma_f32_32x32x16_bf16 v[176:191], a[132:135], v[228:231], v[176:191]
    v_mul_f32 v132, v132, v8
    v_exp_f32 v131, v131
    v_mul_f32 v133, v133, v8
    v_exp_f32 v132, v132
    s_waitcnt lgkmcnt(4)
    v_mfma_f32_32x32x16_bf16 v[160:175], a[8:11], v[232:235], v[160:175]
    s_add_u32 s21, s21, 4096
    buffer_load_dwordx4 a[132:135], v2, s[32:35], s21 offen offset:0 sc1
    ds_read_b128 v[252:255], v6 offset:39936
    v_mul_f32 v134, v134, v8
    v_exp_f32 v133, v133
    v_mul_f32 v135, v135, v8
    v_mfma_f32_32x32x16_bf16 v[176:191], a[136:139], v[232:235], v[176:191]
    v_exp_f32 v134, v134
    v_exp_f32 v135, v135
    v_fma_f32 v128, v128, v9, v9
    s_waitcnt lgkmcnt(4)
    v_mfma_f32_32x32x16_bf16 v[160:175], a[12:15], v[236:239], v[160:175]
    buffer_load_dwordx4 a[136:139], v2, s[32:35], s20 offen offset:1024 sc1
    ds_read_b128 v[224:227], v6 offset:40960
    v_fma_f32 v129, v129, v9, v9
    v_rcp_f32 v128, v128
    v_fma_f32 v130, v130, v9, v9
    v_mfma_f32_32x32x16_bf16 v[176:191], a[140:143], v[236:239], v[176:191]
    v_rcp_f32 v129, v129
    v_fma_f32 v131, v131, v9, v9
    v_rcp_f32 v130, v130
    s_waitcnt lgkmcnt(4)
    v_mfma_f32_32x32x16_bf16 v[160:175], a[16:19], v[240:243], v[160:175]
    buffer_load_dwordx4 a[140:143], v2, s[32:35], s21 offen offset:1024 sc1
    ds_read_b128 v[228:231], v6 offset:41984
    v_fma_f32 v132, v132, v9, v9
    v_rcp_f32 v131, v131
    v_fma_f32 v133, v133, v9, v9
    v_mfma_f32_32x32x16_bf16 v[176:191], a[144:147], v[240:243], v[176:191]
    v_rcp_f32 v132, v132
    v_fma_f32 v134, v134, v9, v9
    v_rcp_f32 v133, v133
    s_waitcnt lgkmcnt(4)
    v_mfma_f32_32x32x16_bf16 v[160:175], a[20:23], v[244:247], v[160:175]
    buffer_load_dwordx4 a[144:147], v2, s[32:35], s20 offen offset:2048 sc1
    ds_read_b128 v[232:235], v6 offset:43008
    v_fma_f32 v135, v135, v9, v9
    v_rcp_f32 v134, v134
    v_rcp_f32 v135, v135
    v_mfma_f32_32x32x16_bf16 v[176:191], a[148:151], v[244:247], v[176:191]
    v_mul_f32 v128, v128, v136
    v_mul_f32 v129, v129, v137
    v_mul_f32 v130, v130, v138
    v_mul_f32 v131, v131, v139
    v_mul_f32 v132, v132, v140
    s_waitcnt lgkmcnt(4)
    v_mfma_f32_32x32x16_bf16 v[160:175], a[24:27], v[248:251], v[160:175]
    buffer_load_dwordx4 a[148:151], v2, s[32:35], s21 offen offset:2048 sc1
    ds_read_b128 v[236:239], v6 offset:44032
    v_mul_f32 v133, v133, v141
    v_mul_f32 v134, v134, v142
    v_mul_f32 v135, v135, v143
    v_cvt_pk_bf16_f32 v128, v128, v129
    v_mfma_f32_32x32x16_bf16 v[176:191], a[152:155], v[248:251], v[176:191]
    v_cvt_pk_bf16_f32 v129, v130, v131
    v_cvt_pk_bf16_f32 v130, v132, v133
    v_cvt_pk_bf16_f32 v131, v134, v135
    buffer_store_dwordx4 v[128:131], v2, s[32:35], s10 offen sc1
    v_mul_f32 v144, v144, v8
    s_waitcnt lgkmcnt(4)
    v_mfma_f32_32x32x16_bf16 v[160:175], a[28:31], v[252:255], v[160:175]
    ds_read_b128 v[240:243], v6 offset:45056
    v_mul_f32 v145, v145, v8
    v_exp_f32 v144, v144
    v_mul_f32 v146, v146, v8
    v_mfma_f32_32x32x16_bf16 v[176:191], a[156:159], v[252:255], v[176:191]
    v_exp_f32 v145, v145
    v_mul_f32 v147, v147, v8
    v_exp_f32 v146, v146
    s_waitcnt lgkmcnt(4)
    v_mfma_f32_32x32x16_bf16 v[160:175], a[32:35], v[224:227], v[160:175]
    ds_read_b128 v[244:247], v6 offset:46080
    s_waitcnt vmcnt(23)
    ds_read2st64_b32 v[208:209], v4 offset0:192 offset1:196
    ds_read2st64_b32 v[210:211], v4 offset0:200 offset1:204
    buffer_load_dwordx4 a[152:155], v2, s[32:35], s20 offen offset:3072 sc1
    s_waitcnt vmcnt(20)
    ds_read2st64_b32 v[212:213], v62 offset0:192 offset1:196
    ds_read2st64_b32 v[214:215], v62 offset0:200 offset1:204
    v_mfma_f32_32x32x16_bf16 v[176:191], a[160:163], v[224:227], v[176:191]
    s_waitcnt lgkmcnt(8)
    v_mfma_f32_32x32x16_bf16 v[160:175], a[36:39], v[228:231], v[160:175]
    buffer_load_dwordx4 a[156:159], v2, s[32:35], s21 offen offset:3072 sc1
    ds_read_b128 v[248:251], v6 offset:47104
    s_waitcnt lgkmcnt(1)
    v_max_u32 v60, v208, v209
    v_max3_u32 v60, v60, v210, v211
    v_max3_u32 v60, v60, v212, v213
    v_max3_u32 v60, v60, v214, v215
    v_mfma_f32_32x32x16_bf16 v[176:191], a[164:167], v[228:231], v[176:191]
    v_cmp_eq_u32 vcc, -1, v60
    s_cbranch_vccnz re_21
ok_22:
    v_mul_f32 v148, v148, v8
    v_exp_f32 v147, v147
    s_add_u32 s20, s20, 4096
    buffer_load_dwordx4 a[160:163], v2, s[32:35], s20 offen offset:0 sc1
    v_mfma_f32_32x32x16_bf16 v[160:175], a[40:43], v[232:235], v[160:175]
    ds_read_b128 v[252:255], v6 offset:48128
    v_mul_f32 v149, v149, v8
    v_exp_f32 v148, v148
    v_mul_f32 v150, v150, v8
    v_mfma_f32_32x32x16_bf16 v[176:191], a[168:171], v[232:235], v[176:191]
    v_exp_f32 v149, v149
    v_mul_f32 v151, v151, v8
    s_add_u32 s21, s21, 4096
    buffer_load_dwordx4 a[164:167], v2, s[32:35], s21 offen offset:0 sc1
    v_exp_f32 v150, v150
    s_barrier
    v_mfma_f32_32x32x16_bf16 v[160:175], a[44:47], v[236:239], v[160:175]
    ds_read_b128 v[224:227], v6 offset:49152
    v_exp_f32 v151, v151
    v_fma_f32 v144, v144, v9, v9
    v_fma_f32 v145, v145, v9, v9
    v_mfma_f32_32x32x16_bf16 v[176:191], a[172:175], v[236:239], v[176:191]
    s_lshl_b32 s98, s71, 27
    s_add_u32 s20, s20, s98
    buffer_load_dwordx4 a[168:171], v2, s[32:35], s20 offen offset:1024 sc1
    v_rcp_f32 v144, v144
    v_fma_f32 v146, v146, v9, v9
    v_rcp_f32 v145, v145
    v_mfma_f32_32x32x16_bf16 v[160:175], a[48:51], v[240:243], v[160:175]
    ds_read_b128 v[228:231], v6 offset:50176
    v_fma_f32 v147, v147, v9, v9
    v_rcp_f32 v146, v146
    v_fma_f32 v148, v148, v9, v9
    v_mfma_f32_32x32x16_bf16 v[176:191], a[176:179], v[240:243], v[176:191]
    s_lshl_b32 s98, s71, 27
    s_add_u32 s21, s21, s98
    buffer_load_dwordx4 a[172:175], v2, s[32:35], s21 offen offset:1024 sc1
    v_rcp_f32 v147, v147
    v_fma_f32 v149, v149, v9, v9
    v_rcp_f32 v148, v148
    v_mfma_f32_32x32x16_bf16 v[160:175], a[52:55], v[244:247], v[160:175]
    ds_read_b128 v[232:235], v6 offset:51200
    v_fma_f32 v150, v150, v9, v9
    v_rcp_f32 v149, v149
    v_fma_f32 v151, v151, v9, v9
    v_mfma_f32_32x32x16_bf16 v[176:191], a[180:183], v[244:247], v[176:191]
    buffer_load_dwordx4 a[176:179], v2, s[32:35], s22 offen offset:0 sc1
    v_rcp_f32 v150, v150
    v_rcp_f32 v151, v151
    v_mul_f32 v144, v144, v152
    s_waitcnt lgkmcnt(4)
    v_mfma_f32_32x32x16_bf16 v[160:175], a[56:59], v[248:251], v[160:175]
    ds_read_b128 v[236:239], v6 offset:52224
    v_mul_f32 v145, v145, v153
    v_mul_f32 v146, v146, v154
    v_mul_f32 v147, v147, v155
    v_mul_f32 v148, v148, v156
    buffer_load_dwordx4 a[180:183], v2, s[32:35], s23 offen offset:0 sc1
    v_mfma_f32_32x32x16_bf16 v[176:191], a[184:187], v[248:251], v[176:191]
    v_mul_f32 v149, v149, v157
    v_mul_f32 v150, v150, v158
    v_mul_f32 v151, v151, v159
    v_cvt_pk_bf16_f32 v144, v144, v145
    v_cvt_pk_bf16_f32 v145, v146, v147
    s_waitcnt lgkmcnt(4)
    v_mfma_f32_32x32x16_bf16 v[160:175], a[60:63], v[252:255], v[160:175]
    ds_read_b128 v[240:243], v6 offset:53248
    v_cvt_pk_bf16_f32 v146, v148, v149
    v_cvt_pk_bf16_f32 v147, v150, v151
    buffer_load_dwordx4 a[184:187], v2, s[32:35], s22 offen offset:1024 sc1
    buffer_store_dwordx4 v[144:147], v2, s[32:35], s11 offen sc1
    v_mfma_f32_32x32x16_bf16 v[176:191], a[188:191], v[252:255], v[176:191]
    s_waitcnt lgkmcnt(4)
    v_mfma_f32_32x32x16_bf16 v[160:175], a[64:67], v[224:227], v[160:175]
    ds_read_b128 v[244:247], v6 offset:54272
    v_mfma_f32_32x32x16_bf16 v[176:191], a[192:195], v[224:227], v[176:191]
    s_waitcnt lgkmcnt(4)
    v_mfma_f32_32x32x16_bf16 v[160:175], a[68:71], v[228:231], v[160:175]
    ds_read_b128 v[248:251], v6 offset:55296
    v_mfma_f32_32x32x16_bf16 v[176:191], a[196:199], v[228:231], v[176:191]
    s_waitcnt lgkmcnt(4)
    v_mfma_f32_32x32x16_bf16 v[160:175], a[72:75], v[232:235], v[160:175]
    buffer_load_dwordx4 a[188:191], v2, s[32:35], s23 offen offset:1024 sc1
    ds_read_b128 v[252:255], v6 offset:56320
    v_mfma_f32_32x32x16_bf16 v[176:191], a[200:203], v[232:235], v[176:191]
    s_waitcnt lgkmcnt(4)
    v_mfma_f32_32x32x16_bf16 v[160:175], a[76:79], v[236:239], v[160:175]
    buffer_load_dwordx4 a[192:195], v2, s[32:35], s22 offen offset:2048 sc1
    ds_read_b128 v[224:227], v6 offset:57344
    v_mfma_f32_32x32x16_bf16 v[176:191], a[204:207], v[236:239], v[176:191]
    s_waitcnt lgkmcnt(4)
    v_mfma_f32_32x32x16_bf16 v[160:175], a[80:83], v[240:243], v[160:175]
    buffer_load_dwordx4 a[196:199], v2, s[32:35], s23 offen offset:2048 sc1
    ds_read_b128 v[228:231], v6 offset:58368
    v_mfma_f32_32x32x16_bf16 v[176:191], a[208:211], v[240:243], v[176:191]
    s_waitcnt lgkmcnt(4)
    v_mfma_f32_32x32x16_bf16 v[160:175], a[84:87], v[244:247], v[160:175]
    buffer_load_dwordx4 a[200:203], v2, s[32:35], s22 offen offset:3072 sc1
    ds_read_b128 v[232:235], v6 offset:59392
    v_mfma_f32_32x32x16_bf16 v[176:191], a[212:215], v[244:247], v[176:191]
    s_waitcnt lgkmcnt(4)
    v_mfma_f32_32x32x16_bf16 v[160:175], a[88:91], v[248:251], v[160:175]
    buffer_load_dwordx4 a[204:207], v2, s[32:35], s23 offen offset:3072 sc1
    ds_read_b128 v[236:239], v6 offset:60416
    v_mfma_f32_32x32x16_bf16 v[176:191], a[216:219], v[248:251], v[176:191]
    s_waitcnt lgkmcnt(4)
    v_mfma_f32_32x32x16_bf16 v[160:175], a[92:95], v[252:255], v[160:175]
    s_add_u32 s22, s22, 4096
    buffer_load_dwordx4 a[208:211], v2, s[32:35], s22 offen offset:0 sc1
    ds_read_b128 v[240:243], v6 offset:61440
    v_mfma_f32_32x32x16_bf16 v[176:191], a[220:223], v[252:255], v[176:191]
    s_waitcnt lgkmcnt(4)
    v_mfma_f32_32x32x16_bf16 v[160:175], a[96:99], v[224:227], v[160:175]
    ds_read_b128 v[244:247], v6 offset:62464
    s_add_u32 s23, s23, 4096
    buffer_load_dwordx4 a[212:215], v2, s[32:35], s23 offen offset:0 sc1
    v_mfma_f32_32x32x16_bf16 v[176:191], a[224:227], v[224:227], v[176:191]
    s_waitcnt lgkmcnt(4)
    v_mfma_f32_32x32x16_bf16 v[160:175], a[100:103], v[228:231], v[160:175]
    ds_read_b128 v[248:251], v6 offset:63488
    v_mfma_f32_32x32x16_bf16 v[176:191], a[228:231], v[228:231], v[176:191]
    buffer_load_dwordx4 a[216:219], v2, s[32:35], s22 offen offset:1024 sc1
    s_waitcnt lgkmcnt(4)
    v_mfma_f32_32x32x16_bf16 v[160:175], a[104:107], v[232:235], v[160:175]
    ds_read_b128 v[252:255], v6 offset:64512
    v_mfma_f32_32x32x16_bf16 v[176:191], a[232:235], v[232:235], v[176:191]
    buffer_load_dwordx4 a[220:223], v2, s[32:35], s23 offen offset:1024 sc1
    s_waitcnt lgkmcnt(4)
    v_mfma_f32_32x32x16_bf16 v[160:175], a[108:111], v[236:239], v[160:175]
    ds_read_b128 v[224:227], v7 offset:0
    v_mfma_f32_32x32x16_bf16 v[176:191], a[236:239], v[236:239], v[176:191]
    buffer_load_dwordx4 a[224:227], v2, s[32:35], s22 offen offset:2048 sc1
    s_waitcnt lgkmcnt(4)
    v_mfma_f32_32x32x16_bf16 v[160:175], a[112:115], v[240:243], v[160:175]
    ds_read_b128 v[228:231], v7 offset:1024
    v_mfma_f32_32x32x16_bf16 v[176:191], a[240:243], v[240:243], v[176:191]
    buffer_load_dwordx4 a[228:231], v2, s[32:35], s23 offen offset:2048 sc1
    s_waitcnt lgkmcnt(4)
    v_mfma_f32_32x32x16_bf16 v[160:175], a[116:119], v[244:247], v[160:175]
    ds_read_b128 v[232:235], v7 offset:2048
    v_mfma_f32_32x32x16_bf16 v[176:191], a[244:247], v[244:247], v[176:191]
    buffer_load_dwordx4 a[232:235], v2, s[32:35], s22 offen offset:3072 sc1
    s_waitcnt lgkmcnt(4)
    v_mfma_f32_32x32x16_bf16 v[160:175], a[120:123], v[248:251], v[160:175]
    ds_read_b128 v[236:239], v7 offset:3072
    v_mfma_f32_32x32x16_bf16 v[176:191], a[248:251], v[248:251], v[176:191]
    buffer_load_dwordx4 a[236:239], v2, s[32:35], s23 offen offset:3072 sc1
    s_waitcnt lgkmcnt(4)
    v_mfma_f32_32x32x16_bf16 v[160:175], a[124:127], v[252:255], v[160:175]
    ds_read_b128 v[240:243], v7 offset:4096
    v_mfma_f32_32x32x16_bf16 v[176:191], a[252:255], v[252:255], v[176:191]
    s_waitcnt vmcnt(40)
    s_lshr_b32 s98, s17, 3
    s_add_u32 s98, s98, 393216
    v_mov_b32 v63, s100
    s_mov_b64 exec, 1
    buffer_store_dword v63, off, s[32:35], s98 sc1
    s_mov_b64 exec, -1
    v_mfma_f32_32x32x16_bf16 v[160:175], v[32:35], v[20:23], v[160:175]
    v_mfma_f32_32x32x16_bf16 v[176:191], v[36:39], v[20:23], v[176:191]
    s_waitcnt lgkmcnt(3)
    v_mfma_f32_32x32x16_bf16 v[128:143], a[0:3], v[224:227], 0
    ds_read_b128 v[244:247], v7 offset:5120
    v_mfma_f32_32x32x16_bf16 v[128:143], a[4:7], v[228:231], v[128:143]
    ds_read_b128 v[248:251], v7 offset:6144
    s_nop 5
    v_mul_f32 v160, v160, v10
    v_mul_f32 v161, v161, v10
    v_exp_f32 v160, v160
    s_waitcnt lgkmcnt(3)
    v_mfma_f32_32x32x16_bf16 v[128:143], a[8:11], v[232:235], v[128:143]
    ds_read_b128 v[252:255], v7 offset:7168
    v_mul_f32 v162, v162, v10
    v_exp_f32 v161, v161
    v_mul_f32 v163, v163, v10
    v_mfma_f32_32x32x16_bf16 v[128:143], a[12:15], v[236:239], v[128:143]
    ds_read_b128 v[224:227], v7 offset:8192
    v_exp_f32 v162, v162
    v_mul_f32 v164, v164, v10
    v_exp_f32 v163, v163
    s_waitcnt lgkmcnt(3)
    v_mfma_f32_32x32x16_bf16 v[128:143], a[16:19], v[240:243], v[128:143]
    ds_read_b128 v[228:231], v7 offset:9216
    v_mul_f32 v165, v165, v10
    v_exp_f32 v164, v164
    v_mul_f32 v166, v166, v10
    v_mfma_f32_32x32x16_bf16 v[128:143], a[20:23], v[244:247], v[128:143]
    ds_read_b128 v[232:235], v7 offset:10240
    v_exp_f32 v165, v165
    v_mul_f32 v167, v167, v10
    v_exp_f32 v166, v166
    s_waitcnt lgkmcnt(3)
    v_mfma_f32_32x32x16_bf16 v[128:143], a[24:27], v[248:251], v[128:143]
    ds_read_b128 v[236:239], v7 offset:11264
    v_exp_f32 v167, v167
    v_fma_f32 v160, v160, v11, v11
    v_fma_f32 v161, v161, v11, v11
    v_mfma_f32_32x32x16_bf16 v[128:143], a[28:31], v[252:255], v[128:143]
    ds_read_b128 v[240:243], v7 offset:12288
    v_rcp_f32 v160, v160
    v_fma_f32 v162, v162, v11, v11
    v_rcp_f32 v161, v161
    s_waitcnt lgkmcnt(3)
    v_mfma_f32_32x32x16_bf16 v[128:143], a[32:35], v[224:227], v[128:143]
    ds_read_b128 v[244:247], v7 offset:13312
    v_fma_f32 v163, v163, v11, v11
    v_rcp_f32 v162, v162
    v_fma_f32 v164, v164, v11, v11
    v_mfma_f32_32x32x16_bf16 v[128:143], a[36:39], v[228:231], v[128:143]
    ds_read_b128 v[248:251], v7 offset:14336
    v_rcp_f32 v163, v163
    v_fma_f32 v165, v165, v11, v11
    v_rcp_f32 v164, v164
    s_waitcnt lgkmcnt(3)
    v_mfma_f32_32x32x16_bf16 v[128:143], a[40:43], v[232:235], v[128:143]
    ds_read_b128 v[252:255], v7 offset:15360
    v_fma_f32 v166, v166, v11, v11
    v_rcp_f32 v165, v165
    v_fma_f32 v167, v167, v11, v11
    v_mfma_f32_32x32x16_bf16 v[128:143], a[44:47], v[236:239], v[128:143]
    ds_read_b128 v[224:227], v7 offset:16384
    v_rcp_f32 v166, v166
    v_rcp_f32 v167, v167
    s_waitcnt lgkmcnt(3)
    v_mfma_f32_32x32x16_bf16 v[128:143], a[48:51], v[240:243], v[128:143]
    ds_read_b128 v[228:231], v7 offset:17408
    v_mul_f32 v160, v160, v168
    v_mul_f32 v161, v161, v169
    v_mul_f32 v162, v162, v170
    v_mul_f32 v163, v163, v171
    v_mfma_f32_32x32x16_bf16 v[128:143], a[52:55], v[244:247], v[128:143]
    ds_read_b128 v[232:235], v7 offset:18432
    v_mul_f32 v164, v164, v172
    v_mul_f32 v165, v165, v173
    v_mul_f32 v166, v166, v174
    v_mul_f32 v167, v167, v175
    s_waitcnt lgkmcnt(3)
    v_mfma_f32_32x32x16_bf16 v[128:143], a[56:59], v[248:251], v[128:143]
    ds_read_b128 v[236:239], v7 offset:19456
    v_cvt_pk_bf16_f32 v160, v160, v161
    v_cvt_pk_bf16_f32 v161, v162, v163
    v_cvt_pk_bf16_f32 v162, v164, v165
    v_cvt_pk_bf16_f32 v163, v166, v167
    v_mfma_f32_32x32x16_bf16 v[128:143], a[60:63], v[252:255], v[128:143]
    ds_read_b128 v[240:243], v7 offset:20480
    buffer_store_dwordx4 v[160:163], v2, s[32:35], s12 offen sc1
    v_mul_f32 v176, v176, v10
    v_mul_f32 v177, v177, v10
    v_exp_f32 v176, v176
    s_waitcnt lgkmcnt(3)
    v_mfma_f32_32x32x16_bf16 v[128:143], a[64:67], v[224:227], v[128:143]
    ds_read_b128 v[244:247], v7 offset:21504
    v_mul_f32 v178, v178, v10
    v_exp_f32 v177, v177
    v_mul_f32 v179, v179, v10
    v_mfma_f32_32x32x16_bf16 v[128:143], a[68:71], v[228:231], v[128:143]
    ds_read_b128 v[248:251], v7 offset:22528
    v_exp_f32 v178, v178
    v_mul_f32 v180, v180, v10
    v_exp_f32 v179, v179
    s_waitcnt lgkmcnt(3)
    v_mfma_f32_32x32x16_bf16 v[128:143], a[72:75], v[232:235], v[128:143]
    ds_read_b128 v[252:255], v7 offset:23552
    v_mul_f32 v181, v181, v10
    v_exp_f32 v180, v180
    v_mul_f32 v182, v182, v10
    v_mfma_f32_32x32x16_bf16 v[128:143], a[76:79], v[236:239], v[128:143]
    ds_read_b128 v[224:227], v7 offset:24576
    v_exp_f32 v181, v181
    v_mul_f32 v183, v183, v10
    v_exp_f32 v182, v182
    s_waitcnt lgkmcnt(3)
    v_mfma_f32_32x32x16_bf16 v[128:143], a[80:83], v[240:243], v[128:143]
    ds_read_b128 v[228:231], v7 offset:25600
    v_exp_f32 v183, v183
    v_fma_f32 v176, v176, v11, v11
    v_fma_f32 v177, v177, v11, v11
    v_mfma_f32_32x32x16_bf16 v[128:143], a[84:87], v[244:247], v[128:143]
    ds_read_b128 v[232:235], v7 offset:26624
    v_rcp_f32 v176, v176
    v_fma_f32 v178, v178, v11, v11
    v_rcp_f32 v177, v177
    s_waitcnt lgkmcnt(3)
    v_mfma_f32_32x32x16_bf16 v[128:143], a[88:91], v[248:251], v[128:143]
    ds_read_b128 v[236:239], v7 offset:27648
    v_fma_f32 v179, v179, v11, v11
    v_rcp_f32 v178, v178
    v_fma_f32 v180, v180, v11, v11
    v_mfma_f32_32x32x16_bf16 v[128:143], a[92:95], v[252:255], v[128:143]
    ds_read_b128 v[240:243], v7 offset:28672
    v_rcp_f32 v179, v179
    v_fma_f32 v181, v181, v11, v11
    v_rcp_f32 v180, v180
    s_waitcnt lgkmcnt(3)
    v_mfma_f32_32x32x16_bf16 v[128:143], a[96:99], v[224:227], v[128:143]
    ds_read_b128 v[244:247], v7 offset:29696
    v_fma_f32 v182, v182, v11, v11
    v_rcp_f32 v181, v181
    v_fma_f32 v183, v183, v11, v11
    v_mfma_f32_32x32x16_bf16 v[128:143], a[100:103], v[228:231], v[128:143]
    ds_read_b128 v[248:251], v7 offset:30720
    v_rcp_f32 v182, v182
    v_rcp_f32 v183, v183
    s_waitcnt lgkmcnt(3)
    v_mfma_f32_32x32x16_bf16 v[128:143], a[104:107], v[232:235], v[128:143]
    buffer_load_dwordx4 v[192:195], v2, s[32:35], s64 offen offset:0 sc1
    ds_read_b128 v[252:255], v7 offset:31744
    v_mul_f32 v176, v176, v184
    v_mul_f32 v177, v177, v185
    v_mul_f32 v178, v178, v186
    v_mul_f32 v179, v179, v187
    v_mfma_f32_32x32x16_bf16 v[128:143], a[108:111], v[236:239], v[128:143]
    ds_read_b128 v[224:227], v7 offset:32768
    buffer_load_dwordx4 v[196:199], v2, s[32:35], s64 offen offset:1024 sc1
    v_mul_f32 v180, v180, v188
    v_mul_f32 v181, v181, v189
    v_mul_f32 v182, v182, v190
    v_mul_f32 v183, v183, v191
    s_waitcnt lgkmcnt(3)
    v_mfma_f32_32x32x16_bf16 v[128:143], a[112:115], v[240:243], v[128:143]
    ds_read_b128 v[228:231], v7 offset:33792
    v_cvt_pk_bf16_f32 v176, v176, v177
    buffer_load_dwordx4 v[200:203], v2, s[32:35], s64 offen offset:2048 sc1
    v_cvt_pk_bf16_f32 v177, v178, v179
    v_cvt_pk_bf16_f32 v178, v180, v181
    v_cvt_pk_bf16_f32 v179, v182, v183
    v_mfma_f32_32x32x16_bf16 v[128:143], a[116:119], v[244:247], v[128:143]
    ds_read_b128 v[232:235], v7 offset:34816
    buffer_store_dwordx4 v[176:179], v2, s[32:35], s13 offen sc1
    s_waitcnt lgkmcnt(3)
    v_mfma_f32_32x32x16_bf16 v[128:143], a[120:123], v[248:251], v[128:143]
    ds_read_b128 v[236:239], v7 offset:35840
    v_mfma_f32_32x32x16_bf16 v[128:143], a[124:127], v[252:255], v[128:143]
    ds_read_b128 v[240:243], v7 offset:36864
    v_mfma_f32_32x32x16_bf16 v[128:143], v[32:35], v[24:27], v[128:143]
    s_waitcnt lgkmcnt(3)
    v_mfma_f32_32x32x16_bf16 v[144:159], a[0:3], v[224:227], 0
    buffer_load_dwordx4 v[204:207], v2, s[32:35], s64 offen offset:3072 sc1
    ds_read_b128 v[244:247], v7 offset:37888
    v_mfma_f32_32x32x16_bf16 v[144:159], a[4:7], v[228:231], v[144:159]
    ds_read_b128 v[248:251], v7 offset:38912
    s_nop 5
    v_mul_f32 v128, v128, v12
    s_add_u32 s74, s64, 4096
    buffer_load_dwordx4 v[208:211], v2, s[32:35], s74 offen offset:0 sc1
    v_mul_f32 v129, v129, v12
    v_exp_f32 v128, v128
    s_waitcnt lgkmcnt(3)
    v_mfma_f32_32x32x16_bf16 v[144:159], a[8:11], v[232:235], v[144:159]
    ds_read_b128 v[252:255], v7 offset:39936
    v_mul_f32 v130, v130, v12
    v_exp_f32 v129, v129
    buffer_load_dwordx4 v[212:215], v2, s[32:35], s74 offen offset:1024 sc1
    v_mul_f32 v131, v131, v12
    v_mfma_f32_32x32x16_bf16 v[144:159], a[12:15], v[236:239], v[144:159]
    ds_read_b128 v[224:227], v7 offset:40960
    v_exp_f32 v130, v130
    v_mul_f32 v132, v132, v12
    v_exp_f32 v131, v131
    buffer_load_dwordx4 v[216:219], v2, s[32:35], s74 offen offset:2048 sc1
    s_waitcnt lgkmcnt(3)
    v_mfma_f32_32x32x16_bf16 v[144:159], a[16:19], v[240:243], v[144:159]
    ds_read_b128 v[228:231], v7 offset:41984
    v_mul_f32 v133, v133, v12
    v_exp_f32 v132, v132
    v_mul_f32 v134, v134, v12
    v_mfma_f32_32x32x16_bf16 v[144:159], a[20:23], v[244:247], v[144:159]
    buffer_load_dwordx4 v[220:223], v2, s[32:35], s74 offen offset:3072 sc1
    ds_read_b128 v[232:235], v7 offset:43008
    v_exp_f32 v133, v133
    v_mul_f32 v135, v135, v12
    v_exp_f32 v134, v134
    s_waitcnt lgkmcnt(3)
    v_mfma_f32_32x32x16_bf16 v[144:159], a[24:27], v[248:251], v[144:159]
    s_add_u32 s74, s64, 8192
    buffer_load_dwordx4 v[40:43], v2, s[32:35], s74 offen offset:0 sc1
    ds_read_b128 v[236:239], v7 offset:44032
    v_exp_f32 v135, v135
    v_fma_f32 v128, v128, v13, v13
    v_fma_f32 v129, v129, v13, v13
    v_mfma_f32_32x32x16_bf16 v[144:159], a[28:31], v[252:255], v[144:159]
    ds_read_b128 v[240:243], v7 offset:45056
    buffer_load_dwordx4 v[44:47], v2, s[32:35], s74 offen offset:1024 sc1
    v_rcp_f32 v128, v128
    v_fma_f32 v130, v130, v13, v13
    v_rcp_f32 v129, v129
    s_waitcnt lgkmcnt(3)
    v_mfma_f32_32x32x16_bf16 v[144:159], a[32:35], v[224:227], v[144:159]
    ds_read_b128 v[244:247], v7 offset:46080
    buffer_load_dwordx4 v[48:51], v2, s[32:35], s74 offen offset:2048 sc1
    v_fma_f32 v131, v131, v13, v13
    v_rcp_f32 v130, v130
    v_fma_f32 v132, v132, v13, v13
    v_mfma_f32_32x32x16_bf16 v[144:159], a[36:39], v[228:231], v[144:159]
    ds_read_b128 v[248:251], v7 offset:47104
    v_rcp_f32 v131, v131
    buffer_load_dwordx4 v[52:55], v2, s[32:35], s74 offen offset:3072 sc1
    v_fma_f32 v133, v133, v13, v13
    v_rcp_f32 v132, v132
    s_waitcnt lgkmcnt(3)
    v_mfma_f32_32x32x16_bf16 v[144:159], a[40:43], v[232:235], v[144:159]
    ds_read_b128 v[252:255], v7 offset:48128
    v_fma_f32 v134, v134, v13, v13
    v_rcp_f32 v133, v133
    s_add_u32 s74, s64, 12288
    buffer_load_dwordx4 v[56:59], v2, s[32:35], s74 offen offset:0 sc1
    v_fma_f32 v135, v135, v13, v13
    v_mfma_f32_32x32x16_bf16 v[144:159], a[44:47], v[236:239], v[144:159]
    ds_read_b128 v[224:227], v7 offset:49152
    v_rcp_f32 v134, v134
    v_rcp_f32 v135, v135
    s_waitcnt lgkmcnt(3)
    v_mfma_f32_32x32x16_bf16 v[144:159], a[48:51], v[240:243], v[144:159]
    s_lshl_b32 s98, s71, 10
    s_sub_u32 s74, s74, s98
    buffer_load_dwordx4 v[16:19], v2, s[32:35], s74 offen offset:1024 sc1
    ds_read_b128 v[228:231], v7 offset:50176
    v_mul_f32 v128, v128, v136
    v_mul_f32 v129, v129, v137
    v_mul_f32 v130, v130, v138
    v_mul_f32 v131, v131, v139
    v_mfma_f32_32x32x16_bf16 v[144:159], a[52:55], v[244:247], v[144:159]
    ds_read_b128 v[232:235], v7 offset:51200
    s_lshr_b32 s98, s68, 6
    s_sub_u32 s98, s98, -163840
    buffer_load_dword v63, off, s[32:35], s98 sc1
    v_mul_f32 v132, v132, v140
    v_mul_f32 v133, v133, v141
    v_mul_f32 v134, v134, v142
    v_mul_f32 v135, v135, v143
    s_waitcnt lgkmcnt(3)
    v_mfma_f32_32x32x16_bf16 v[144:159], a[56:59], v[248:251], v[144:159]
    ds_read_b128 v[236:239], v7 offset:52224
    v_cvt_pk_bf16_f32 v128, v128, v129
    v_cvt_pk_bf16_f32 v129, v130, v131
    v_cvt_pk_bf16_f32 v130, v132, v133
    v_cvt_pk_bf16_f32 v131, v134, v135
    v_mfma_f32_32x32x16_bf16 v[144:159], a[60:63], v[252:255], v[144:159]
    ds_read_b128 v[240:243], v7 offset:53248
    buffer_store_dwordx4 v[128:131], v2, s[32:35], s14 offen sc1
    s_waitcnt lgkmcnt(3)
    v_mfma_f32_32x32x16_bf16 v[144:159], a[64:67], v[224:227], v[144:159]
    s_branch S_6
T_6:
    s_branch L_back
S_6:
    ds_read_b128 v[244:247], v7 offset:54272
    v_mfma_f32_32x32x16_bf16 v[144:159], a[68:71], v[228:231], v[144:159]
    ds_read_b128 v[248:251], v7 offset:55296
    s_waitcnt lgkmcnt(3)
    v_mfma_f32_32x32x16_bf16 v[144:159], a[72:75], v[232:235], v[144:159]
    ds_read_b128 v[252:255], v7 offset:56320
    v_mfma_f32_32x32x16_bf16 v[144:159], a[76:79], v[236:239], v[144:159]
    ds_read_b128 v[224:227], v7 offset:57344
    s_waitcnt lgkmcnt(3)
    v_mfma_f32_32x32x16_bf16 v[144:159], a[80:83], v[240:243], v[144:159]
    ds_read_b128 v[228:231], v7 offset:58368
    v_mfma_f32_32x32x16_bf16 v[144:159], a[84:87], v[244:247], v[144:159]
    ds_read_b128 v[232:235], v7 offset:59392
    s_waitcnt lgkmcnt(3)
    v_mfma_f32_32x32x16_bf16 v[144:159], a[88:91], v[248:251], v[144:159]
    ds_read_b128 v[236:239], v7 offset:60416
    v_mfma_f32_32x32x16_bf16 v[144:159], a[92:95], v[252:255], v[144:159]
    ds_read_b128 v[240:243], v7 offset:61440
    s_waitcnt lgkmcnt(3)
    v_mfma_f32_32x32x16_bf16 v[144:159], a[96:99], v[224:227], v[144:159]
    buffer_load_dwordx4 v[20:23], v2, s[32:35], s65 offen offset:0 sc1
    ds_read_b128 v[244:247], v7 offset:62464
    s_waitcnt vmcnt(3)
    v_max_u32 v60, v192, v196
    v_max3_u32 v60, v60, v200, v204
    v_max3_u32 v60, v60, v208, v212
    v_max3_u32 v60, v60, v216, v220
    v_mfma_f32_32x32x16_bf16 v[144:159], a[100:103], v[228:231], v[144:159]
    buffer_load_dwordx4 v[36:39], v2, s[32:35], s65 offen offset:1024 sc1
    ds_read_b128 v[248:251], v7 offset:63488
    v_max3_u32 v60, v60, v40, v44
    v_max3_u32 v60, v60, v48, v52
    v_max3_u32 v60, v60, v56, v16
    v_cmp_eq_u32 vcc, -1, v60
    s_cbranch_vccnz re_23
ok_24:
    s_waitcnt lgkmcnt(3)
    v_mfma_f32_32x32x16_bf16 v[144:159], a[104:107], v[232:235], v[144:159]
    buffer_load_dwordx4 v[160:163], v2, s[32:35], s65 offen offset:2048 sc1
    ds_read_b128 v[252:255], v7 offset:64512
    v_mfma_f32_32x32x16_bf16 v[144:159], a[108:111], v[236:239], v[144:159]
    s_waitcnt lgkmcnt(2)
    v_mfma_f32_32x32x16_bf16 v[144:159], a[112:115], v[240:243], v[144:159]
    buffer_load_dwordx4 v[164:167], v2, s[32:35], s65 offen offset:3072 sc1
    s_waitcnt vmcnt(5)
    v_cmp_ne_u32 vcc, s100, v63
    s_cbranch_vccnz re_25
ok_26:
    v_mfma_f32_32x32x16_bf16 v[144:159], a[116:119], v[244:247], v[144:159]
    s_waitcnt lgkmcnt(0)
    v_mfma_f32_32x32x16_bf16 v[144:159], a[120:123], v[248:251], v[144:159]
    s_add_u32 s75, s65, 4096
    buffer_load_dwordx4 v[168:171], v2, s[32:35], s75 offen offset:0 sc1
    v_mfma_f32_32x32x16_bf16 v[144:159], a[124:127], v[252:255], v[144:159]
    v_mfma_f32_32x32x16_bf16 v[144:159], v[32:35], v[28:31], v[144:159]
    buffer_load_dwordx4 v[172:175], v2, s[32:35], s75 offen offset:1024 sc1
    v_mfma_f32_32x32x16_bf16 v[224:239], v[64:67], v[192:195], 0
    s_nop 9
    v_mul_f32 v144, v144, v14
    buffer_load_dwordx4 v[24:27], v2, s[32:35], s75 offen offset:2048 sc1
    v_mfma_f32_32x32x16_bf16 v[240:255], v[68:71], v[192:195], 0
    v_mul_f32 v145, v145, v14
    v_exp_f32 v144, v144
    v_mul_f32 v146, v146, v14
    v_exp_f32 v145, v145
    v_mfma_f32_32x32x16_bf16 v[224:239], v[72:75], v[196:199], v[224:239]
    buffer_load_dwordx4 v[176:179], v2, s[32:35], s75 offen offset:3072 sc1
    v_mul_f32 v147, v147, v14
    v_exp_f32 v146, v146
    v_mul_f32 v148, v148, v14
    v_exp_f32 v147, v147
    v_mfma_f32_32x32x16_bf16 v[240:255], v[76:79], v[196:199], v[240:255]
    v_mul_f32 v149, v149, v14
    s_add_u32 s75, s65, 8192
    buffer_load_dwordx4 v[180:183], v2, s[32:35], s75 offen offset:0 sc1
    v_exp_f32 v148, v148
    v_mul_f32 v150, v150, v14
    v_exp_f32 v149, v149
    v_mfma_f32_32x32x16_bf16 v[224:239], v[80:83], v[200:203], v[224:239]
    v_mul_f32 v151, v151, v14
    v_exp_f32 v150, v150
    buffer_load_dwordx4 v[184:187], v2, s[32:35], s75 offen offset:1024 sc1
    v_exp_f32 v151, v151
    v_mfma_f32_32x32x16_bf16 v[240:255], v[84:87], v[200:203], v[240:255]
    v_fma_f32 v144, v144, v15, v15
    v_fma_f32 v145, v145, v15, v15
    v_rcp_f32 v144, v144
    v_fma_f32 v146, v146, v15, v15
    buffer_load_dwordx4 v[188:191], v2, s[32:35], s75 offen offset:2048 sc1
    v_mfma_f32_32x32x16_bf16 v[224:239], v[88:91], v[204:207], v[224:239]
    v_rcp_f32 v145, v145
    v_fma_f32 v147, v147, v15, v15
    v_rcp_f32 v146, v146
    v_mfma_f32_32x32x16_bf16 v[240:255], v[92:95], v[204:207], v[240:255]
    buffer_load_dwordx4 v[28:31], v2, s[32:35], s75 offen offset:3072 sc1
    v_fma_f32 v148, v148, v15, v15
    v_rcp_f32 v147, v147
    v_fma_f32 v149, v149, v15, v15
    v_rcp_f32 v148, v148
    v_mfma_f32_32x32x16_bf16 v[224:239], v[96:99], v[208:211], v[224:239]
    v_fma_f32 v150, v150, v15, v15
    s_add_u32 s75, s65, 12288
    buffer_load_dwordx4 v[32:35], v2, s[32:35], s75 offen offset:0 sc1
    v_rcp_f32 v149, v149
    v_fma_f32 v151, v151, v15, v15
    v_rcp_f32 v150, v150
    v_mfma_f32_32x32x16_bf16 v[240:255], v[100:103], v[208:211], v[240:255]
    v_rcp_f32 v151, v151
    s_lshl_b32 s98, s71, 10
    s_sub_u32 s75, s75, s98
    buffer_load_dwordx4 v[192:195], v2, s[32:35], s75 offen offset:1024 sc1
    v_mul_f32 v144, v144, v152
    v_mul_f32 v145, v145, v153
    v_mul_f32 v146, v146, v154
    v_mfma_f32_32x32x16_bf16 v[224:239], v[104:107], v[212:215], v[224:239]
    v_mul_f32 v147, v147, v155
    v_mul_f32 v148, v148, v156
    v_mul_f32 v149, v149, v157
    v_mul_f32 v150, v150, v158
    v_mul_f32 v151, v151, v159
    v_mfma_f32_32x32x16_bf16 v[240:255], v[108:111], v[212:215], v[240:255]
    v_cvt_pk_bf16_f32 v144, v144, v145
    v_cvt_pk_bf16_f32 v145, v146, v147
    v_cvt_pk_bf16_f32 v146, v148, v149
    v_cvt_pk_bf16_f32 v147, v150, v151
    buffer_store_dwordx4 v[144:147], v2, s[32:35], s15 offen sc1
    v_mfma_f32_32x32x16_bf16 v[224:239], v[112:115], v[216:219], v[224:239]
    v_mfma_f32_32x32x16_bf16 v[240:255], v[116:119], v[216:219], v[240:255]
    v_mfma_f32_32x32x16_bf16 v[224:239], v[120:123], v[220:223], v[224:239]
    v_mfma_f32_32x32x16_bf16 v[240:255], v[124:127], v[220:223], v[240:255]
    v_mfma_f32_32x32x16_bf16 v[224:239], a[128:131], v[40:43], v[224:239]
    v_mfma_f32_32x32x16_bf16 v[240:255], a[132:135], v[40:43], v[240:255]
    v_mfma_f32_32x32x16_bf16 v[224:239], a[136:139], v[44:47], v[224:239]
    v_mfma_f32_32x32x16_bf16 v[240:255], a[140:143], v[44:47], v[240:255]
    v_mfma_f32_32x32x16_bf16 v[224:239], a[144:147], v[48:51], v[224:239]
    v_mfma_f32_32x32x16_bf16 v[240:255], a[148:151], v[48:51], v[240:255]
    v_mfma_f32_32x32x16_bf16 v[224:239], a[152:155], v[52:55], v[224:239]
    v_mfma_f32_32x32x16_bf16 v[240:255], a[156:159], v[52:55], v[240:255]
    v_mfma_f32_32x32x16_bf16 v[224:239], a[160:163], v[56:59], v[224:239]
    v_mfma_f32_32x32x16_bf16 v[240:255], a[164:167], v[56:59], v[240:255]
    v_mfma_f32_32x32x16_bf16 v[224:239], a[168:171], v[16:19], v[224:239]
    buffer_load_dwordx4 v[196:199], v2, s[32:35], s66 offen offset:0 sc1
    s_waitcnt vmcnt(2)
    v_max_u32 v60, v20, v36
    v_max3_u32 v60, v60, v160, v164
    v_max3_u32 v60, v60, v168, v172
    v_max3_u32 v60, v60, v24, v176
    v_max3_u32 v60, v60, v180, v184
    v_mfma_f32_32x32x16_bf16 v[240:255], a[172:175], v[16:19], v[240:255]
    v_max3_u32 v60, v60, v188, v28
    buffer_load_dwordx4 v[200:203], v2, s[32:35], s66 offen offset:1024 sc1
    v_max3_u32 v60, v60, v32, v192
    v_cmp_eq_u32 vcc, -1, v60
    s_cbranch_vccnz re_27
ok_28:
    v_mfma_f32_32x32x16_bf16 v[128:143], v[64:67], v[20:23], 0
    v_mfma_f32_32x32x16_bf16 v[144:159], v[68:71], v[20:23], 0
    buffer_load_dwordx4 v[204:207], v2, s[32:35], s66 offen offset:2048 sc1
    v_mfma_f32_32x32x16_bf16 v[128:143], v[72:75], v[36:39], v[128:143]
    v_mfma_f32_32x32x16_bf16 v[144:159], v[76:79], v[36:39], v[144:159]
    buffer_load_dwordx4 v[208:211], v2, s[32:35], s66 offen offset:3072 sc1
    v_mfma_f32_32x32x16_bf16 v[128:143], v[80:83], v[160:163], v[128:143]
    v_mfma_f32_32x32x16_bf16 v[144:159], v[84:87], v[160:163], v[144:159]
    s_add_u32 s76, s66, 4096
    buffer_load_dwordx4 v[212:215], v2, s[32:35], s76 offen offset:0 sc1
    v_mfma_f32_32x32x16_bf16 v[128:143], v[88:91], v[164:167], v[128:143]
    v_lshrrev_b32 v4, 5, v1
    v_lshlrev_b32 v4, 4, v4
    v_and_b32 v5, 31, v1
    v_lshl_add_u32 v5, v5, 10, v4
    v_add_u32 v5, s69, v5
    buffer_load_dwordx4 v[216:219], v2, s[32:35], s76 offen offset:1024 sc1
    v_mfma_f32_32x32x16_bf16 v[144:159], v[92:95], v[164:167], v[144:159]
    v_add_u32 v4, s70, v4
    ds_read_b128 v[72:75], v4
    ds_read_b128 v[76:79], v4 offset:32
    s_barrier
    s_xor_b32 s58, s3, 0
    v_mfma_f32_32x32x16_bf16 v[128:143], v[96:99], v[168:171], v[128:143]
    buffer_load_dwordx4 v[220:223], v2, s[32:35], s76 offen offset:2048 sc1
    s_mul_i32 s58, s58, 12288
    v_add_u32 v6, s58, v2
    s_xor_b32 s58, s3, 1
    s_mul_i32 s58, s58, 12288
    v_add_u32 v7, s58, v2
    v_mfma_f32_32x32x16_bf16 v[144:159], v[100:103], v[168:171], v[144:159]
    s_xor_b32 s58, s3, 2
    s_mul_i32 s58, s58, 12288
    buffer_load_dwordx4 v[40:43], v2, s[32:35], s76 offen offset:3072 sc1
    v_add_u32 v8, s58, v2
    s_xor_b32 s58, s3, 3
    s_mul_i32 s58, s58, 12288
    v_mfma_f32_32x32x16_bf16 v[128:143], v[104:107], v[172:175], v[128:143]
    v_add_u32 v9, s58, v2
    v_mfma_f32_32x32x16_bf16 v[144:159], v[108:111], v[172:175], v[144:159]
    v_mfma_f32_32x32x16_bf16 v[128:143], v[112:115], v[24:27], v[128:143]
    v_mfma_f32_32x32x16_bf16 v[144:159], v[116:119], v[24:27], v[144:159]
    v_mfma_f32_32x32x16_bf16 v[128:143], v[120:123], v[176:179], v[128:143]
    v_mfma_f32_32x32x16_bf16 v[144:159], v[124:127], v[176:179], v[144:159]
    v_mfma_f32_32x32x16_bf16 v[128:143], a[128:131], v[180:183], v[128:143]
    buffer_load_dwordx4 v[44:47], v2, s[32:35], s67 offen offset:0 sc1
    v_mfma_f32_32x32x16_bf16 v[144:159], a[132:135], v[180:183], v[144:159]
    v_mfma_f32_32x32x16_bf16 v[128:143], a[136:139], v[184:187], v[128:143]
    buffer_load_dwordx4 v[48:51], v2, s[32:35], s67 offen offset:1024 sc1
    v_mfma_f32_32x32x16_bf16 v[144:159], a[140:143], v[184:187], v[144:159]
    v_mfma_f32_32x32x16_bf16 v[128:143], a[144:147], v[188:191], v[128:143]
    buffer_load_dwordx4 v[52:55], v2, s[32:35], s67 offen offset:2048 sc1
    v_mfma_f32_32x32x16_bf16 v[144:159], a[148:151], v[188:191], v[144:159]
    v_mfma_f32_32x32x16_bf16 v[128:143], a[152:155], v[28:31], v[128:143]
    buffer_load_dwordx4 v[56:59], v2, s[32:35], s67 offen offset:3072 sc1
    v_mfma_f32_32x32x16_bf16 v[144:159], a[156:159], v[28:31], v[144:159]
    v_mfma_f32_32x32x16_bf16 v[128:143], a[160:163], v[32:35], v[128:143]
    s_add_u32 s77, s67, 4096
    buffer_load_dwordx4 v[16:19], v2, s[32:35], s77 offen offset:0 sc1
    s_waitcnt vmcnt(5)
    v_max_u32 v60, v196, v200
    v_max3_u32 v60, v60, v204, v208
    v_max3_u32 v60, v60, v212, v216
    v_max3_u32 v60, v60, v220, v40
    v_cmp_eq_u32 vcc, -1, v60
    s_cbranch_vccnz re_29
ok_30:
    v_mfma_f32_32x32x16_bf16 v[144:159], a[164:167], v[32:35], v[144:159]
    buffer_load_dwordx4 v[20:23], v2, s[32:35], s77 offen offset:1024 sc1
    v_mfma_f32_32x32x16_bf16 v[128:143], a[168:171], v[192:195], v[128:143]
    v_mfma_f32_32x32x16_bf16 v[144:159], a[172:175], v[192:195], v[144:159]
    buffer_load_dwordx4 v[36:39], v2, s[32:35], s77 offen offset:2048 sc1
    v_mfma_f32_32x32x16_bf16 v[224:239], a[176:179], v[196:199], v[224:239]
    v_mfma_f32_32x32x16_bf16 v[240:255], a[180:183], v[196:199], v[240:255]
    buffer_load_dwordx4 v[160:163], v2, s[32:35], s77 offen offset:3072 sc1
    v_mfma_f32_32x32x16_bf16 v[224:239], a[184:187], v[200:203], v[224:239]
    v_mfma_f32_32x32x16_bf16 v[240:255], a[188:191], v[200:203], v[240:255]
    buffer_load_dwordx4 v[64:67], v2, s[32:35], s68 offen sc1
    v_mfma_f32_32x32x16_bf16 v[224:239], a[192:195], v[204:207], v[224:239]
    v_mfma_f32_32x32x16_bf16 v[240:255], a[196:199], v[204:207], v[240:255]
    buffer_load_dwordx4 v[68:71], v2, s[32:35], s68 offen offset:1024 sc1
    v_mfma_f32_32x32x16_bf16 v[224:239], a[200:203], v[208:211], v[224:239]
    v_mfma_f32_32x32x16_bf16 v[240:255], a[204:207], v[208:211], v[240:255]
    v_mfma_f32_32x32x16_bf16 v[224:239], a[208:211], v[212:215], v[224:239]
    v_mfma_f32_32x32x16_bf16 v[240:255], a[212:215], v[212:215], v[240:255]
    v_mfma_f32_32x32x16_bf16 v[224:239], a[216:219], v[216:219], v[224:239]
    v_mfma_f32_32x32x16_bf16 v[240:255], a[220:223], v[216:219], v[240:255]
    v_mfma_f32_32x32x16_bf16 v[224:239], a[224:227], v[220:223], v[224:239]
    v_mfma_f32_32x32x16_bf16 v[240:255], a[228:231], v[220:223], v[240:255]
    v_mfma_f32_32x32x16_bf16 v[224:239], a[232:235], v[40:43], v[224:239]
    s_waitcnt vmcnt(2)
    v_max_u32 v60, v44, v48
    v_max3_u32 v60, v60, v52, v56
    v_max3_u32 v60, v60, v16, v20
    v_max3_u32 v60, v60, v36, v160
    v_cmp_eq_u32 vcc, -1, v60
    s_cbranch_vccnz re_31
ok_32:
    v_mfma_f32_32x32x16_bf16 v[240:255], a[236:239], v[40:43], v[240:255]
    s_bitcmp1_b32 s3, 1
    s_cbranch_scc1 L_var1
    v_mfma_f32_32x32x16_bf16 v[128:143], a[176:179], v[44:47], v[128:143]
    v_mfma_f32_32x32x16_bf16 v[128:143], a[184:187], v[48:51], v[128:143]
    s_nop 7
    ds_write_b128 v7, v[240:243] offset:0
    v_mfma_f32_32x32x16_bf16 v[128:143], a[192:195], v[52:55], v[128:143]
    ds_write_b128 v7, v[244:247] offset:1024
    v_mfma_f32_32x32x16_bf16 v[128:143], a[200:203], v[56:59], v[128:143]
    ds_write_b128 v7, v[248:251] offset:2048
    v_mfma_f32_32x32x16_bf16 v[128:143], a[208:211], v[16:19], v[128:143]
    ds_write_b128 v7, v[252:255] offset:3072
    v_mfma_f32_32x32x16_bf16 v[128:143], a[216:219], v[20:23], v[128:143]
    v_mfma_f32_32x32x16_bf16 v[128:143], a[224:227], v[36:39], v[128:143]
    v_mfma_f32_32x32x16_bf16 v[128:143], a[232:235], v[160:163], v[128:143]
    v_mfma_f32_32x32x16_bf16 v[144:159], a[180:183], v[44:47], v[144:159]
    v_mfma_f32_32x32x16_bf16 v[144:159], a[188:191], v[48:51], v[144:159]
    s_nop 9
    ds_write_b128 v8, v[128:131] offset:4096
    v_mfma_f32_32x32x16_bf16 v[144:159], a[196:199], v[52:55], v[144:159]
    ds_write_b128 v8, v[132:135] offset:5120
    v_mfma_f32_32x32x16_bf16 v[144:159], a[204:207], v[56:59], v[144:159]
    ds_write_b128 v8, v[136:139] offset:6144
    v_mfma_f32_32x32x16_bf16 v[144:159], a[212:215], v[16:19], v[144:159]
    ds_write_b128 v8, v[140:143] offset:7168
    v_mfma_f32_32x32x16_bf16 v[144:159], a[220:223], v[20:23], v[144:159]
    v_mfma_f32_32x32x16_bf16 v[144:159], a[228:231], v[36:39], v[144:159]
    v_mfma_f32_32x32x16_bf16 v[144:159], a[236:239], v[160:163], v[144:159]
    s_nop 11
    ds_write_b128 v9, v[144:147] offset:8192
    ds_write_b128 v9, v[148:151] offset:9216
    ds_write_b128 v9, v[152:155] offset:10240
    ds_write_b128 v9, v[156:159] offset:11264
    s_waitcnt lgkmcnt(0)
    s_barrier
    ds_read_b128 v[16:19], v6 offset:0
    ds_read_b128 v[20:23], v6 offset:1024
    ds_read_b128 v[24:27], v6 offset:2048
    ds_read_b128 v[28:31], v6 offset:3072
    ds_read_b128 v[32:35], v6 offset:4096
    ds_read_b128 v[36:39], v6 offset:5120
    ds_read_b128 v[40:43], v6 offset:6144
    ds_read_b128 v[44:47], v6 offset:7168
    ds_read_b128 v[48:51], v6 offset:8192
    ds_read_b128 v[52:55], v6 offset:9216
    ds_read_b128 v[56:59], v6 offset:10240
    ds_read_b128 v[60:63], v6 offset:11264
    s_waitcnt vmcnt(0)
    v_lshlrev_b32 v80, 16, v64
    v_and_b32 v81, 0xffff0000, v64
    v_lshlrev_b32 v82, 16, v65
    v_and_b32 v83, 0xffff0000, v65
    v_lshlrev_b32 v84, 16, v66
    v_and_b32 v85, 0xffff0000, v66
    v_lshlrev_b32 v86, 16, v67
    v_and_b32 v87, 0xffff0000, v67
    v_lshlrev_b32 v88, 16, v68
    v_and_b32 v89, 0xffff0000, v68
    v_lshlrev_b32 v90, 16, v69
    v_and_b32 v91, 0xffff0000, v69
    v_lshlrev_b32 v92, 16, v70
    v_and_b32 v93, 0xffff0000, v70
    v_lshlrev_b32 v94, 16, v71
    v_and_b32 v95, 0xffff0000, v71
    v_lshlrev_b32 v96, 16, v72
    v_and_b32 v97, 0xffff0000, v72
    v_lshlrev_b32 v98, 16, v73
    v_and_b32 v99, 0xffff0000, v73
    v_lshlrev_b32 v100, 16, v74
    v_and_b32 v101, 0xffff0000, v74
    v_lshlrev_b32 v102, 16, v75
    v_and_b32 v103, 0xffff0000, v75
    v_lshlrev_b32 v104, 16, v76
    v_and_b32 v105, 0xffff0000, v76
    v_lshlrev_b32 v106, 16, v77
    v_and_b32 v107, 0xffff0000, v77
    v_lshlrev_b32 v108, 16, v78
    v_and_b32 v109, 0xffff0000, v78
    v_lshlrev_b32 v110, 16, v79
    v_and_b32 v111, 0xffff0000, v79
    s_waitcnt lgkmcnt(8)
    v_pk_add_f32 v[224:225], v[224:225], v[16:17]
    v_pk_add_f32 v[226:227], v[226:227], v[18:19]
    v_pk_add_f32 v[228:229], v[228:229], v[20:21]
    v_pk_add_f32 v[230:231], v[230:231], v[22:23]
    v_pk_add_f32 v[232:233], v[232:233], v[24:25]
    v_pk_add_f32 v[234:235], v[234:235], v[26:27]
    v_pk_add_f32 v[236:237], v[236:237], v[28:29]
    v_pk_add_f32 v[238:239], v[238:239], v[30:31]
    s_waitcnt lgkmcnt(4)
    v_pk_add_f32 v[224:225], v[224:225], v[32:33]
    v_pk_add_f32 v[226:227], v[226:227], v[34:35]
    v_pk_add_f32 v[228:229], v[228:229], v[36:37]
    v_pk_add_f32 v[230:231], v[230:231], v[38:39]
    v_pk_add_f32 v[232:233], v[232:233], v[40:41]
    v_pk_add_f32 v[234:235], v[234:235], v[42:43]
    v_pk_add_f32 v[236:237], v[236:237], v[44:45]
    v_pk_add_f32 v[238:239], v[238:239], v[46:47]
    s_waitcnt lgkmcnt(0)
    v_pk_add_f32 v[224:225], v[224:225], v[48:49]
    v_pk_add_f32 v[226:227], v[226:227], v[50:51]
    v_pk_add_f32 v[228:229], v[228:229], v[52:53]
    v_pk_add_f32 v[230:231], v[230:231], v[54:55]
    v_pk_add_f32 v[232:233], v[232:233], v[56:57]
    v_pk_add_f32 v[234:235], v[234:235], v[58:59]
    v_pk_add_f32 v[236:237], v[236:237], v[60:61]
    v_pk_add_f32 v[238:239], v[238:239], v[62:63]
    v_pk_fma_f32 v[80:81], v[224:225], v[96:97], v[80:81]
    v_pk_fma_f32 v[82:83], v[226:227], v[98:99], v[82:83]
    v_pk_fma_f32 v[84:85], v[228:229], v[100:101], v[84:85]
    v_pk_fma_f32 v[86:87], v[230:231], v[102:103], v[86:87]
    v_pk_fma_f32 v[88:89], v[232:233], v[104:105], v[88:89]
    v_pk_fma_f32 v[90:91], v[234:235], v[106:107], v[90:91]
    v_pk_fma_f32 v[92:93], v[236:237], v[108:109], v[92:93]
    v_pk_fma_f32 v[94:95], v[238:239], v[110:111], v[94:95]
    v_cvt_pk_bf16_f32 v64, v80, v81
    v_cvt_pk_bf16_f32 v65, v82, v83
    v_cvt_pk_bf16_f32 v66, v84, v85
    v_cvt_pk_bf16_f32 v67, v86, v87
    v_cvt_pk_bf16_f32 v68, v88, v89
    v_cvt_pk_bf16_f32 v69, v90, v91
    v_cvt_pk_bf16_f32 v70, v92, v93
    v_cvt_pk_bf16_f32 v71, v94, v95
    global_store_dwordx4 v5, v[64:67], s[24:25]
    global_store_dwordx4 v5, v[68:71], s[24:25] offset:32
    s_or_b32 s60, s2, s3
    s_cmp_eq_u32 s60, 0
    s_mov_b32 s61, 32768
    s_cselect_b32 s60, s61, 0x8000000
    v_mov_b32 v3, s100
    s_mov_b64 exec, 1
    buffer_store_dword v3, v2, s[32:35], s60 offen sc1
    s_endpgm
T_7:
    s_branch L_back
L_var1:
    v_mfma_f32_32x32x16_bf16 v[144:159], a[180:183], v[44:47], v[144:159]
    v_mfma_f32_32x32x16_bf16 v[144:159], a[188:191], v[48:51], v[144:159]
    ds_write_b128 v8, v[224:227] offset:4096
    v_mfma_f32_32x32x16_bf16 v[144:159], a[196:199], v[52:55], v[144:159]
    ds_write_b128 v8, v[228:231] offset:5120
    v_mfma_f32_32x32x16_bf16 v[144:159], a[204:207], v[56:59], v[144:159]
    ds_write_b128 v8, v[232:235] offset:6144
    v_mfma_f32_32x32x16_bf16 v[144:159], a[212:215], v[16:19], v[144:159]
    ds_write_b128 v8, v[236:239] offset:7168
    v_mfma_f32_32x32x16_bf16 v[144:159], a[220:223], v[20:23], v[144:159]
    ds_write_b128 v9, v[240:243] offset:8192
    v_mfma_f32_32x32x16_bf16 v[144:159], a[228:231], v[36:39], v[144:159]
    ds_write_b128 v9, v[244:247] offset:9216
    v_mfma_f32_32x32x16_bf16 v[144:159], a[236:239], v[160:163], v[144:159]
    ds_write_b128 v9, v[248:251] offset:10240
    v_mfma_f32_32x32x16_bf16 v[128:143], a[176:179], v[44:47], v[128:143]
    ds_write_b128 v9, v[252:255] offset:11264
    v_mfma_f32_32x32x16_bf16 v[128:143], a[184:187], v[48:51], v[128:143]
    s_nop 7
    ds_write_b128 v7, v[144:147] offset:0
    v_mfma_f32_32x32x16_bf16 v[128:143], a[192:195], v[52:55], v[128:143]
    ds_write_b128 v7, v[148:151] offset:1024
    v_mfma_f32_32x32x16_bf16 v[128:143], a[200:203], v[56:59], v[128:143]
    ds_write_b128 v7, v[152:155] offset:2048
    v_mfma_f32_32x32x16_bf16 v[128:143], a[208:211], v[16:19], v[128:143]
    ds_write_b128 v7, v[156:159] offset:3072
    v_mfma_f32_32x32x16_bf16 v[128:143], a[216:219], v[20:23], v[128:143]
    v_mfma_f32_32x32x16_bf16 v[128:143], a[224:227], v[36:39], v[128:143]
    v_mfma_f32_32x32x16_bf16 v[128:143], a[232:235], v[160:163], v[128:143]
    s_waitcnt lgkmcnt(0)
    s_barrier
    ds_read_b128 v[16:19], v6 offset:0
    ds_read_b128 v[20:23], v6 offset:1024
    ds_read_b128 v[24:27], v6 offset:2048
    ds_read_b128 v[28:31], v6 offset:3072
    ds_read_b128 v[32:35], v6 offset:4096
    ds_read_b128 v[36:39], v6 offset:5120
    ds_read_b128 v[40:43], v6 offset:6144
    ds_read_b128 v[44:47], v6 offset:7168
    ds_read_b128 v[48:51], v6 offset:8192
    ds_read_b128 v[52:55], v6 offset:9216
    ds_read_b128 v[56:59], v6 offset:10240
    ds_read_b128 v[60:63], v6 offset:11264
    s_waitcnt vmcnt(0)
    v_lshlrev_b32 v80, 16, v64
    v_and_b32 v81, 0xffff0000, v64
    v_lshlrev_b32 v82, 16, v65
    v_and_b32 v83, 0xffff0000, v65
    v_lshlrev_b32 v84, 16, v66
    v_and_b32 v85, 0xffff0000, v66
    v_lshlrev_b32 v86, 16, v67
    v_and_b32 v87, 0xffff0000, v67
    v_lshlrev_b32 v88, 16, v68
    v_and_b32 v89, 0xffff0000, v68
    v_lshlrev_b32 v90, 16, v69
    v_and_b32 v91, 0xffff0000, v69
    v_lshlrev_b32 v92, 16, v70
    v_and_b32 v93, 0xffff0000, v70
    v_lshlrev_b32 v94, 16, v71
    v_and_b32 v95, 0xffff0000, v71
    v_lshlrev_b32 v96, 16, v72
    v_and_b32 v97, 0xffff0000, v72
    v_lshlrev_b32 v98, 16, v73
    v_and_b32 v99, 0xffff0000, v73
    v_lshlrev_b32 v100, 16, v74
    v_and_b32 v101, 0xffff0000, v74
    v_lshlrev_b32 v102, 16, v75
    v_and_b32 v103, 0xffff0000, v75
    v_lshlrev_b32 v104, 16, v76
    v_and_b32 v105, 0xffff0000, v76
    v_lshlrev_b32 v106, 16, v77
    v_and_b32 v107, 0xffff0000, v77
    v_lshlrev_b32 v108, 16, v78
    v_and_b32 v109, 0xffff0000, v78
    v_lshlrev_b32 v110, 16, v79
    v_and_b32 v111, 0xffff0000, v79
    s_waitcnt lgkmcnt(8)
    v_pk_add_f32 v[128:129], v[128:129], v[16:17]
    v_pk_add_f32 v[130:131], v[130:131], v[18:19]
    v_pk_add_f32 v[132:133], v[132:133], v[20:21]
    v_pk_add_f32 v[134:135], v[134:135], v[22:23]
    v_pk_add_f32 v[136:137], v[136:137], v[24:25]
    v_pk_add_f32 v[138:139], v[138:139], v[26:27]
    v_pk_add_f32 v[140:141], v[140:141], v[28:29]
    v_pk_add_f32 v[142:143], v[142:143], v[30:31]
    s_waitcnt lgkmcnt(4)
    v_pk_add_f32 v[128:129], v[128:129], v[32:33]
    v_pk_add_f32 v[130:131], v[130:131], v[34:35]
    v_pk_add_f32 v[132:133], v[132:133], v[36:37]
    v_pk_add_f32 v[134:135], v[134:135], v[38:39]
    v_pk_add_f32 v[136:137], v[136:137], v[40:41]
    v_pk_add_f32 v[138:139], v[138:139], v[42:43]
    v_pk_add_f32 v[140:141], v[140:141], v[44:45]
    v_pk_add_f32 v[142:143], v[142:143], v[46:47]
    s_waitcnt lgkmcnt(0)
    v_pk_add_f32 v[128:129], v[128:129], v[48:49]
    v_pk_add_f32 v[130:131], v[130:131], v[50:51]
    v_pk_add_f32 v[132:133], v[132:133], v[52:53]
    v_pk_add_f32 v[134:135], v[134:135], v[54:55]
    v_pk_add_f32 v[136:137], v[136:137], v[56:57]
    v_pk_add_f32 v[138:139], v[138:139], v[58:59]
    v_pk_add_f32 v[140:141], v[140:141], v[60:61]
    v_pk_add_f32 v[142:143], v[142:143], v[62:63]
    v_pk_fma_f32 v[80:81], v[128:129], v[96:97], v[80:81]
    v_pk_fma_f32 v[82:83], v[130:131], v[98:99], v[82:83]
    v_pk_fma_f32 v[84:85], v[132:133], v[100:101], v[84:85]
    v_pk_fma_f32 v[86:87], v[134:135], v[102:103], v[86:87]
    v_pk_fma_f32 v[88:89], v[136:137], v[104:105], v[88:89]
    v_pk_fma_f32 v[90:91], v[138:139], v[106:107], v[90:91]
    v_pk_fma_f32 v[92:93], v[140:141], v[108:109], v[92:93]
    v_pk_fma_f32 v[94:95], v[142:143], v[110:111], v[94:95]
    v_cvt_pk_bf16_f32 v64, v80, v81
    v_cvt_pk_bf16_f32 v65, v82, v83
    v_cvt_pk_bf16_f32 v66, v84, v85
    v_cvt_pk_bf16_f32 v67, v86, v87
    v_cvt_pk_bf16_f32 v68, v88, v89
    v_cvt_pk_bf16_f32 v69, v90, v91
    v_cvt_pk_bf16_f32 v70, v92, v93
    v_cvt_pk_bf16_f32 v71, v94, v95
    global_store_dwordx4 v5, v[64:67], s[24:25]
    global_store_dwordx4 v5, v[68:71], s[24:25] offset:32
L_exit:
    s_endpgm
re_1:
    s_mov_b32 s99, 0
re_1b:
    buffer_load_dwordx4 v[16:19], v2, s[32:35], s12 offen sc1
    buffer_load_dwordx4 v[20:23], v2, s[32:35], s13 offen sc1
    buffer_load_dwordx4 v[24:27], v2, s[32:35], s14 offen sc1
    buffer_load_dwordx4 v[28:31], v2, s[32:35], s15 offen sc1
    buffer_load_dwordx4 v[32:35], v12, s[32:35], s52 offen sc1
    s_waitcnt vmcnt(0)
    v_xor_b32 v40, s100, v16
    v_xor_b32 v41, s100, v17
    v_bitop3_b32 v40, v18, s100, v40 bitop3:0xbe
    v_bitop3_b32 v41, v19, s100, v41 bitop3:0xbe
    v_bitop3_b32 v40, v20, s100, v40 bitop3:0xbe
    v_bitop3_b32 v41, v21, s100, v41 bitop3:0xbe
    v_bitop3_b32 v40, v22, s100, v40 bitop3:0xbe
    v_bitop3_b32 v41, v23, s100, v41 bitop3:0xbe
    v_bitop3_b32 v40, v24, s100, v40 bitop3:0xbe
    v_bitop3_b32 v41, v25, s100, v41 bitop3:0xbe
    v_bitop3_b32 v40, v26, s100, v40 bitop3:0xbe
    v_bitop3_b32 v41, v27, s100, v41 bitop3:0xbe
    v_bitop3_b32 v40, v28, s100, v40 bitop3:0xbe
    v_bitop3_b32 v41, v29, s100, v41 bitop3:0xbe
    v_bitop3_b32 v40, v30, s100, v40 bitop3:0xbe
    v_bitop3_b32 v41, v31, s100, v41 bitop3:0xbe
    v_bitop3_b32 v40, v32, s100, v40 bitop3:0xbe
    v_bitop3_b32 v41, v33, s100, v41 bitop3:0xbe
    v_bitop3_b32 v40, v34, s100, v40 bitop3:0xbe
    v_bitop3_b32 v41, v35, s100, v41 bitop3:0xbe
    v_or_b32 v40, v40, v41
    v_and_b32 v40, 63, v40
    v_cmp_ne_u32 vcc, 0, v40
    s_add_u32 s99, s99, 1
    s_cmp_gt_u32 s99, 0x8000
    s_cbranch_scc1 ok_2
    s_cbranch_vccnz re_1b
    s_branch ok_2
re_3:
    s_mov_b32 s99, 0
re_3b:
    buffer_load_dwordx2 v[88:89], v90, s[32:35], 0 offen sc1
    s_waitcnt vmcnt(0)
    v_xor_b32 v88, s100, v88
    v_bitop3_b32 v88, v89, s100, v88 bitop3:0xbe
    v_cmp_ne_u32 vcc, 0, v88
    s_add_u32 s99, s99, 1
    s_cmp_gt_u32 s99, 0x8000
    s_cbranch_scc1 ok_4
    s_cbranch_vccnz re_3b
    s_branch ok_4
re_5:
    s_mov_b32 s99, 0
re_5b:
    buffer_load_dwordx4 v[80:83], v2, s[32:35], s20 offen sc1
    buffer_load_dwordx4 v[84:87], v2, s[32:35], s20 offen offset:1024 sc1
    s_waitcnt vmcnt(0)
    v_xor_b32 v32, s100, v82
    v_bitop3_b32 v32, v83, s100, v32 bitop3:0xbe
    v_bitop3_b32 v32, v86, s100, v32 bitop3:0xbe
    v_bitop3_b32 v32, v87, s100, v32 bitop3:0xbe
    v_cmp_ne_u32 vcc, 0, v32
    s_add_u32 s99, s99, 1
    s_cmp_gt_u32 s99, 0x8000
    s_cbranch_scc1 ok_6
    s_cbranch_vccnz re_5b
    s_branch ok_6
re_7:
    s_mov_b32 s99, 0
re_7b:
    buffer_load_dwordx4 v[16:19], v4, s[32:35], s82 offen sc1
    buffer_load_dwordx4 v[20:23], v4, s[32:35], s82 offen offset:2048 sc1
    buffer_load_dwordx4 v[24:27], v4, s[32:35], s22 offen sc1
    buffer_load_dwordx4 v[28:31], v4, s[32:35], s22 offen offset:2048 sc1
    s_waitcnt vmcnt(0)
    v_xor_b32 v32, s100, v16
    v_xor_b32 v33, s100, v17
    v_bitop3_b32 v32, v18, s100, v32 bitop3:0xbe
    v_bitop3_b32 v33, v19, s100, v33 bitop3:0xbe
    v_bitop3_b32 v32, v20, s100, v32 bitop3:0xbe
    v_bitop3_b32 v33, v21, s100, v33 bitop3:0xbe
    v_bitop3_b32 v32, v22, s100, v32 bitop3:0xbe
    v_bitop3_b32 v33, v23, s100, v33 bitop3:0xbe
    v_bitop3_b32 v32, v24, s100, v32 bitop3:0xbe
    v_bitop3_b32 v33, v25, s100, v33 bitop3:0xbe
    v_bitop3_b32 v32, v26, s100, v32 bitop3:0xbe
    v_bitop3_b32 v33, v27, s100, v33 bitop3:0xbe
    v_bitop3_b32 v32, v28, s100, v32 bitop3:0xbe
    v_bitop3_b32 v33, v29, s100, v33 bitop3:0xbe
    v_bitop3_b32 v32, v30, s100, v32 bitop3:0xbe
    v_bitop3_b32 v33, v31, s100, v33 bitop3:0xbe
    v_or_b32 v32, v32, v33
    v_and_b32 v32, s81, v32
    v_cmp_ne_u32 vcc, 0, v32
    s_add_u32 s99, s99, 1
    s_cmp_gt_u32 s99, 0x8000
    s_cbranch_scc1 ok_8
    s_cbranch_vccnz re_7b
    s_branch ok_8
re_9:
    s_mov_b32 s99, 0
re_9b:
    buffer_load_dwordx4 v[64:67], v2, s[32:35], s48 offen offset:0 sc1
    buffer_load_dwordx4 v[68:71], v2, s[32:35], s48 offen offset:1024 sc1
    buffer_load_dwordx4 v[72:75], v2, s[32:35], s48 offen offset:2048 sc1
    buffer_load_dwordx4 v[76:79], v2, s[32:35], s48 offen offset:3072 sc1
    buffer_load_dwordx4 v[80:83], v2, s[32:35], s49 offen offset:0 sc1
    buffer_load_dwordx4 v[84:87], v2, s[32:35], s49 offen offset:1024 sc1
    buffer_load_dwordx4 v[88:91], v2, s[32:35], s49 offen offset:2048 sc1
    buffer_load_dwordx4 v[92:95], v2, s[32:35], s49 offen offset:3072 sc1
    buffer_load_dwordx4 v[96:99], v2, s[32:35], s50 offen offset:0 sc1
    buffer_load_dwordx4 v[100:103], v2, s[32:35], s50 offen offset:1024 sc1
    buffer_load_dwordx4 v[104:107], v2, s[32:35], s50 offen offset:2048 sc1
    buffer_load_dwordx4 v[108:111], v2, s[32:35], s50 offen offset:3072 sc1
    buffer_load_dwordx4 v[112:115], v2, s[32:35], s51 offen offset:0 sc1
    buffer_load_dwordx4 v[116:119], v2, s[32:35], s51 offen offset:1024 sc1
    buffer_load_dwordx4 v[120:123], v2, s[32:35], s51 offen offset:2048 sc1
    buffer_load_dwordx4 v[124:127], v2, s[32:35], s51 offen offset:3072 sc1
    s_waitcnt vmcnt(0)
    v_xor_b32 v64, s101, v64
    v_xor_b32 v67, s101, v67
    v_xor_b32 v68, s101, v68
    v_xor_b32 v71, s101, v71
    v_xor_b32 v72, s101, v72
    v_xor_b32 v75, s101, v75
    v_xor_b32 v76, s101, v76
    v_xor_b32 v79, s101, v79
    v_xor_b32 v80, s101, v80
    v_xor_b32 v83, s101, v83
    v_xor_b32 v84, s101, v84
    v_xor_b32 v87, s101, v87
    v_xor_b32 v88, s101, v88
    v_xor_b32 v91, s101, v91
    v_xor_b32 v92, s101, v92
    v_xor_b32 v95, s101, v95
    v_xor_b32 v96, s101, v96
    v_xor_b32 v99, s101, v99
    v_xor_b32 v100, s101, v100
    v_xor_b32 v103, s101, v103
    v_xor_b32 v104, s101, v104
    v_xor_b32 v107, s101, v107
    v_xor_b32 v108, s101, v108
    v_xor_b32 v111, s101, v111
    v_xor_b32 v112, s101, v112
    v_xor_b32 v115, s101, v115
    v_xor_b32 v116, s101, v116
    v_xor_b32 v119, s101, v119
    v_xor_b32 v120, s101, v120
    v_xor_b32 v123, s101, v123
    v_xor_b32 v124, s101, v124
    v_xor_b32 v127, s101, v127
    v_or_b32 v10, v64, v67
    v_or_b32 v11, v68, v71
    v_or3_b32 v10, v10, v72, v75
    v_or3_b32 v11, v11, v76, v79
    v_or3_b32 v10, v10, v80, v83
    v_or3_b32 v11, v11, v84, v87
    v_or3_b32 v10, v10, v88, v91
    v_or3_b32 v11, v11, v92, v95
    v_or3_b32 v10, v10, v96, v99
    v_or3_b32 v11, v11, v100, v103
    v_or3_b32 v10, v10, v104, v107
    v_or3_b32 v11, v11, v108, v111
    v_or3_b32 v10, v10, v112, v115
    v_or3_b32 v11, v11, v116, v119
    v_or3_b32 v10, v10, v120, v123
    v_or3_b32 v11, v11, v124, v127
    v_or_b32 v10, v10, v11
    v_and_b32 v10, 0xc000c000, v10
    v_cmp_ne_u32 vcc, 0, v10
    s_add_u32 s99, s99, 1
    s_cmp_gt_u32 s99, 0x8000
    s_cbranch_scc1 ok_10
    s_cbranch_vccnz re_9b
    s_branch ok_10
re_11:
    s_mov_b32 s99, 0
re_11b:
    buffer_load_dwordx4 v[128:131], v2, s[32:35], s52 offen offset:0 sc1
    buffer_load_dwordx4 v[132:135], v2, s[32:35], s52 offen offset:1024 sc1
    buffer_load_dwordx4 v[136:139], v2, s[32:35], s52 offen offset:2048 sc1
    buffer_load_dwordx4 v[140:143], v2, s[32:35], s52 offen offset:3072 sc1
    buffer_load_dwordx4 v[144:147], v2, s[32:35], s53 offen offset:0 sc1
    buffer_load_dwordx4 v[148:151], v2, s[32:35], s53 offen offset:1024 sc1
    buffer_load_dwordx4 v[152:155], v2, s[32:35], s53 offen offset:2048 sc1
    buffer_load_dwordx4 v[156:159], v2, s[32:35], s53 offen offset:3072 sc1
    buffer_load_dwordx4 v[160:163], v7, s[32:35], s54 offen sc1
    buffer_load_dwordx4 v[164:167], v7, s[32:35], s54 offen offset:256 sc1
    s_waitcnt vmcnt(0)
    v_max3_u32 v10, v128, v129, v130
    v_max3_u32 v11, v131, v132, v133
    v_max3_u32 v11, v11, v134, v135
    v_max3_u32 v10, v10, v136, v137
    v_max3_u32 v11, v11, v138, v139
    v_max3_u32 v10, v10, v140, v141
    v_max3_u32 v11, v11, v142, v143
    v_max3_u32 v10, v10, v144, v145
    v_max3_u32 v11, v11, v146, v147
    v_max3_u32 v10, v10, v148, v149
    v_max3_u32 v11, v11, v150, v151
    v_max3_u32 v10, v10, v152, v153
    v_max3_u32 v11, v11, v154, v155
    v_max3_u32 v10, v10, v156, v157
    v_max3_u32 v11, v11, v158, v159
    v_max3_u32 v10, v10, v160, v161
    v_max3_u32 v11, v11, v162, v163
    v_max3_u32 v10, v10, v164, v165
    v_max3_u32 v11, v11, v166, v167
    v_max_u32 v10, v10, v11
    v_cmp_eq_u32 vcc, -1, v10
    s_add_u32 s99, s99, 1
    s_cmp_gt_u32 s99, 0x8000
    s_cbranch_scc1 ok_12
    s_cbranch_vccnz re_11b
    s_branch ok_12
re_13:
    s_mov_b32 s99, 0
re_13b:
    s_mov_b32 s78, m0
    s_mov_b32 s79, s91
    s_add_u32 s91, s18, 0
    s_add_u32 m0, s55, 0
    s_nop 0
    buffer_load_dwordx4 v2, s[32:35], s91 offen offset:0 sc1 lds
    buffer_load_dwordx4 v2, s[32:35], s91 offen offset:1024 sc1 lds
    buffer_load_dwordx4 v2, s[32:35], s91 offen offset:2048 sc1 lds
    buffer_load_dwordx4 v2, s[32:35], s91 offen offset:3072 sc1 lds
    s_add_u32 s91, s18, 65536
    s_add_u32 m0, s55, 65536
    s_nop 0
    buffer_load_dwordx4 v2, s[32:35], s91 offen offset:0 sc1 lds
    buffer_load_dwordx4 v2, s[32:35], s91 offen offset:1024 sc1 lds
    buffer_load_dwordx4 v2, s[32:35], s91 offen offset:2048 sc1 lds
    buffer_load_dwordx4 v2, s[32:35], s91 offen offset:3072 sc1 lds
    s_mov_b32 m0, s78
    s_mov_b32 s91, s79
    s_waitcnt vmcnt(0)
    ds_read2st64_b32 v[208:209], v4 offset0:0 offset1:4
    ds_read2st64_b32 v[210:211], v4 offset0:8 offset1:12
    ds_read2st64_b32 v[212:213], v62 offset0:0 offset1:4
    ds_read2st64_b32 v[214:215], v62 offset0:8 offset1:12
    s_waitcnt lgkmcnt(0)
    v_max_u32 v60, v208, v209
    v_max3_u32 v60, v60, v210, v211
    v_max3_u32 v60, v60, v212, v213
    v_max3_u32 v60, v60, v214, v215
    v_cmp_eq_u32 vcc, -1, v60
    s_add_u32 s99, s99, 1
    s_cmp_gt_u32 s99, 0x8000
    s_cbranch_scc1 ok_14
    s_cbranch_vccnz re_13b
    s_branch ok_14
re_15:
    s_mov_b32 s99, 0
re_15b:
    s_mov_b32 s78, m0
    s_mov_b32 s79, s91
    s_add_u32 s91, s18, 16384
    s_add_u32 m0, s55, 16384
    s_nop 0
    buffer_load_dwordx4 v2, s[32:35], s91 offen offset:0 sc1 lds
    buffer_load_dwordx4 v2, s[32:35], s91 offen offset:1024 sc1 lds
    buffer_load_dwordx4 v2, s[32:35], s91 offen offset:2048 sc1 lds
    buffer_load_dwordx4 v2, s[32:35], s91 offen offset:3072 sc1 lds
    s_add_u32 s91, s18, 81920
    s_add_u32 m0, s55, 81920
    s_nop 0
    buffer_load_dwordx4 v2, s[32:35], s91 offen offset:0 sc1 lds
    buffer_load_dwordx4 v2, s[32:35], s91 offen offset:1024 sc1 lds
    buffer_load_dwordx4 v2, s[32:35], s91 offen offset:2048 sc1 lds
    buffer_load_dwordx4 v2, s[32:35], s91 offen offset:3072 sc1 lds
    s_mov_b32 m0, s78
    s_mov_b32 s91, s79
    s_waitcnt vmcnt(0)
    ds_read2st64_b32 v[208:209], v4 offset0:64 offset1:68
    ds_read2st64_b32 v[210:211], v4 offset0:72 offset1:76
    ds_read2st64_b32 v[212:213], v62 offset0:64 offset1:68
    ds_read2st64_b32 v[214:215], v62 offset0:72 offset1:76
    s_waitcnt lgkmcnt(0)
    v_max_u32 v60, v208, v209
    v_max3_u32 v60, v60, v210, v211
    v_max3_u32 v60, v60, v212, v213
    v_max3_u32 v60, v60, v214, v215
    v_cmp_eq_u32 vcc, -1, v60
    s_add_u32 s99, s99, 1
    s_cmp_gt_u32 s99, 0x8000
    s_cbranch_scc1 ok_16
    s_cbranch_vccnz re_15b
    s_branch ok_16
re_17:
    s_mov_b32 s99, 0
re_17b:
    buffer_load_dwordx2 v[40:41], v9, s[32:35], s19 offen offset:0 sc1
    buffer_load_dwordx2 v[42:43], v9, s[32:35], s19 offen offset:256 sc1
    buffer_load_dwordx2 v[44:45], v9, s[32:35], s19 offen offset:512 sc1
    buffer_load_dwordx2 v[46:47], v9, s[32:35], s19 offen offset:768 sc1
    buffer_load_dwordx2 v[48:49], v9, s[32:35], s19 offen offset:1024 sc1
    buffer_load_dwordx2 v[50:51], v9, s[32:35], s19 offen offset:1280 sc1
    buffer_load_dwordx2 v[52:53], v9, s[32:35], s19 offen offset:1536 sc1
    buffer_load_dwordx2 v[54:55], v9, s[32:35], s19 offen offset:1792 sc1
    s_waitcnt vmcnt(0)
    v_xor_b32 v60, s100, v40
    v_bitop3_b32 v60, v41, s100, v60 bitop3:0xbe
    v_bitop3_b32 v60, v42, s100, v60 bitop3:0xbe
    v_bitop3_b32 v60, v43, s100, v60 bitop3:0xbe
    v_bitop3_b32 v60, v44, s100, v60 bitop3:0xbe
    v_bitop3_b32 v60, v45, s100, v60 bitop3:0xbe
    v_bitop3_b32 v60, v46, s100, v60 bitop3:0xbe
    v_bitop3_b32 v60, v47, s100, v60 bitop3:0xbe
    v_bitop3_b32 v60, v48, s100, v60 bitop3:0xbe
    v_bitop3_b32 v60, v49, s100, v60 bitop3:0xbe
    v_bitop3_b32 v60, v50, s100, v60 bitop3:0xbe
    v_bitop3_b32 v60, v51, s100, v60 bitop3:0xbe
    v_bitop3_b32 v60, v52, s100, v60 bitop3:0xbe
    v_bitop3_b32 v60, v53, s100, v60 bitop3:0xbe
    v_bitop3_b32 v60, v54, s100, v60 bitop3:0xbe
    v_bitop3_b32 v60, v55, s100, v60 bitop3:0xbe
    v_and_b32 v60, 63, v60
    v_cmp_ne_u32 vcc, 0, v60
    s_add_u32 s99, s99, 1
    s_cmp_gt_u32 s99, 0x8000
    s_cbranch_scc1 ok_18
    s_cbranch_vccnz re_17b
    s_branch ok_18
re_19:
    s_mov_b32 s99, 0
re_19b:
    s_mov_b32 s78, m0
    s_mov_b32 s79, s91
    s_add_u32 s91, s18, 32768
    s_add_u32 m0, s55, 32768
    s_nop 0
    buffer_load_dwordx4 v2, s[32:35], s91 offen offset:0 sc1 lds
    buffer_load_dwordx4 v2, s[32:35], s91 offen offset:1024 sc1 lds
    buffer_load_dwordx4 v2, s[32:35], s91 offen offset:2048 sc1 lds
    buffer_load_dwordx4 v2, s[32:35], s91 offen offset:3072 sc1 lds
    s_add_u32 s91, s18, 98304
    s_add_u32 m0, s55, 98304
    s_nop 0
    buffer_load_dwordx4 v2, s[32:35], s91 offen offset:0 sc1 lds
    buffer_load_dwordx4 v2, s[32:35], s91 offen offset:1024 sc1 lds
    buffer_load_dwordx4 v2, s[32:35], s91 offen offset:2048 sc1 lds
    buffer_load_dwordx4 v2, s[32:35], s91 offen offset:3072 sc1 lds
    s_mov_b32 m0, s78
    s_mov_b32 s91, s79
    s_waitcnt vmcnt(0)
    ds_read2st64_b32 v[208:209], v4 offset0:128 offset1:132
    ds_read2st64_b32 v[210:211], v4 offset0:136 offset1:140
    ds_read2st64_b32 v[212:213], v62 offset0:128 offset1:132
    ds_read2st64_b32 v[214:215], v62 offset0:136 offset1:140
    s_waitcnt lgkmcnt(0)
    v_max_u32 v60, v208, v209
    v_max3_u32 v60, v60, v210, v211
    v_max3_u32 v60, v60, v212, v213
    v_max3_u32 v60, v60, v214, v215
    v_cmp_eq_u32 vcc, -1, v60
    s_add_u32 s99, s99, 1
    s_cmp_gt_u32 s99, 0x8000
    s_cbranch_scc1 ok_20
    s_cbranch_vccnz re_19b
    s_branch ok_20
re_21:
    s_mov_b32 s99, 0
re_21b:
    s_mov_b32 s78, m0
    s_mov_b32 s79, s91
    s_add_u32 s91, s18, 49152
    s_add_u32 m0, s55, 49152
    s_nop 0
    buffer_load_dwordx4 v2, s[32:35], s91 offen offset:0 sc1 lds
    buffer_load_dwordx4 v2, s[32:35], s91 offen offset:1024 sc1 lds
    buffer_load_dwordx4 v2, s[32:35], s91 offen offset:2048 sc1 lds
    buffer_load_dwordx4 v2, s[32:35], s91 offen offset:3072 sc1 lds
    s_add_u32 s91, s18, 114688
    s_add_u32 m0, s55, 114688
    s_nop 0
    buffer_load_dwordx4 v2, s[32:35], s91 offen offset:0 sc1 lds
    buffer_load_dwordx4 v2, s[32:35], s91 offen offset:1024 sc1 lds
    buffer_load_dwordx4 v2, s[32:35], s91 offen offset:2048 sc1 lds
    buffer_load_dwordx4 v2, s[32:35], s91 offen offset:3072 sc1 lds
    s_mov_b32 m0, s78
    s_mov_b32 s91, s79
    s_waitcnt vmcnt(0)
    ds_read2st64_b32 v[208:209], v4 offset0:192 offset1:196
    ds_read2st64_b32 v[210:211], v4 offset0:200 offset1:204
    ds_read2st64_b32 v[212:213], v62 offset0:192 offset1:196
    ds_read2st64_b32 v[214:215], v62 offset0:200 offset1:204
    s_waitcnt lgkmcnt(0)
    v_max_u32 v60, v208, v209
    v_max3_u32 v60, v60, v210, v211
    v_max3_u32 v60, v60, v212, v213
    v_max3_u32 v60, v60, v214, v215
    v_cmp_eq_u32 vcc, -1, v60
    s_add_u32 s99, s99, 1
    s_cmp_gt_u32 s99, 0x8000
    s_cbranch_scc1 ok_22
    s_cbranch_vccnz re_21b
    s_branch ok_22
re_23:
    s_mov_b32 s99, 0
re_23b:
    buffer_load_dwordx4 v[192:195], v2, s[32:35], s64 offen offset:0 sc1
    buffer_load_dwordx4 v[196:199], v2, s[32:35], s64 offen offset:1024 sc1
    buffer_load_dwordx4 v[200:203], v2, s[32:35], s64 offen offset:2048 sc1
    buffer_load_dwordx4 v[204:207], v2, s[32:35], s64 offen offset:3072 sc1
    s_add_u32 s74, s64, 4096
    buffer_load_dwordx4 v[208:211], v2, s[32:35], s74 offen offset:0 sc1
    buffer_load_dwordx4 v[212:215], v2, s[32:35], s74 offen offset:1024 sc1
    buffer_load_dwordx4 v[216:219], v2, s[32:35], s74 offen offset:2048 sc1
    buffer_load_dwordx4 v[220:223], v2, s[32:35], s74 offen offset:3072 sc1
    s_add_u32 s74, s64, 8192
    buffer_load_dwordx4 v[40:43], v2, s[32:35], s74 offen offset:0 sc1
    buffer_load_dwordx4 v[44:47], v2, s[32:35], s74 offen offset:1024 sc1
    buffer_load_dwordx4 v[48:51], v2, s[32:35], s74 offen offset:2048 sc1
    buffer_load_dwordx4 v[52:55], v2, s[32:35], s74 offen offset:3072 sc1
    s_add_u32 s74, s64, 12288
    buffer_load_dwordx4 v[56:59], v2, s[32:35], s74 offen offset:0 sc1
    s_lshl_b32 s98, s71, 10
    s_sub_u32 s74, s74, s98
    buffer_load_dwordx4 v[16:19], v2, s[32:35], s74 offen offset:1024 sc1
    s_waitcnt vmcnt(0)
    v_max_u32 v60, v192, v196
    v_max3_u32 v60, v60, v200, v204
    v_max3_u32 v60, v60, v208, v212
    v_max3_u32 v60, v60, v216, v220
    v_max3_u32 v60, v60, v40, v44
    v_max3_u32 v60, v60, v48, v52
    v_max3_u32 v60, v60, v56, v16
    v_cmp_eq_u32 vcc, -1, v60
    s_add_u32 s99, s99, 1
    s_cmp_gt_u32 s99, 0x8000
    s_cbranch_scc1 ok_24
    s_cbranch_vccnz re_23b
    s_branch ok_24
re_25:
    s_mov_b32 s99, 0
re_25b:
    s_lshr_b32 s98, s68, 6
    s_sub_u32 s98, s98, -163840
    buffer_load_dword v63, off, s[32:35], s98 sc1
    s_waitcnt vmcnt(0)
    v_cmp_ne_u32 vcc, s100, v63
    s_add_u32 s99, s99, 1
    s_cmp_gt_u32 s99, 0x8000
    s_cbranch_scc1 ok_26
    s_cbranch_vccnz re_25b
    s_branch ok_26
re_27:
    s_mov_b32 s99, 0
re_27b:
    buffer_load_dwordx4 v[20:23], v2, s[32:35], s65 offen offset:0 sc1
    buffer_load_dwordx4 v[36:39], v2, s[32:35], s65 offen offset:1024 sc1
    buffer_load_dwordx4 v[160:163], v2, s[32:35], s65 offen offset:2048 sc1
    buffer_load_dwordx4 v[164:167], v2, s[32:35], s65 offen offset:3072 sc1
    s_add_u32 s75, s65, 4096
    buffer_load_dwordx4 v[168:171], v2, s[32:35], s75 offen offset:0 sc1
    buffer_load_dwordx4 v[172:175], v2, s[32:35], s75 offen offset:1024 sc1
    buffer_load_dwordx4 v[24:27], v2, s[32:35], s75 offen offset:2048 sc1
    buffer_load_dwordx4 v[176:179], v2, s[32:35], s75 offen offset:3072 sc1
    s_add_u32 s75, s65, 8192
    buffer_load_dwordx4 v[180:183], v2, s[32:35], s75 offen offset:0 sc1
    buffer_load_dwordx4 v[184:187], v2, s[32:35], s75 offen offset:1024 sc1
    buffer_load_dwordx4 v[188:191], v2, s[32:35], s75 offen offset:2048 sc1
    buffer_load_dwordx4 v[28:31], v2, s[32:35], s75 offen offset:3072 sc1
    s_add_u32 s75, s65, 12288
    buffer_load_dwordx4 v[32:35], v2, s[32:35], s75 offen offset:0 sc1
    s_lshl_b32 s98, s71, 10
    s_sub_u32 s75, s75, s98
    buffer_load_dwordx4 v[192:195], v2, s[32:35], s75 offen offset:1024 sc1
    s_waitcnt vmcnt(0)
    v_max_u32 v60, v20, v36
    v_max3_u32 v60, v60, v160, v164
    v_max3_u32 v60, v60, v168, v172
    v_max3_u32 v60, v60, v24, v176
    v_max3_u32 v60, v60, v180, v184
    v_max3_u32 v60, v60, v188, v28
    v_max3_u32 v60, v60, v32, v192
    v_cmp_eq_u32 vcc, -1, v60
    s_add_u32 s99, s99, 1
    s_cmp_gt_u32 s99, 0x8000
    s_cbranch_scc1 ok_28
    s_cbranch_vccnz re_27b
    s_branch ok_28
re_29:
    s_mov_b32 s99, 0
re_29b:
    buffer_load_dwordx4 v[196:199], v2, s[32:35], s66 offen offset:0 sc1
    buffer_load_dwordx4 v[200:203], v2, s[32:35], s66 offen offset:1024 sc1
    buffer_load_dwordx4 v[204:207], v2, s[32:35], s66 offen offset:2048 sc1
    buffer_load_dwordx4 v[208:211], v2, s[32:35], s66 offen offset:3072 sc1
    s_add_u32 s76, s66, 4096
    buffer_load_dwordx4 v[212:215], v2, s[32:35], s76 offen offset:0 sc1
    buffer_load_dwordx4 v[216:219], v2, s[32:35], s76 offen offset:1024 sc1
    buffer_load_dwordx4 v[220:223], v2, s[32:35], s76 offen offset:2048 sc1
    buffer_load_dwordx4 v[40:43], v2, s[32:35], s76 offen offset:3072 sc1
    s_waitcnt vmcnt(0)
    v_max_u32 v60, v196, v200
    v_max3_u32 v60, v60, v204, v208
    v_max3_u32 v60, v60, v212, v216
    v_max3_u32 v60, v60, v220, v40
    v_cmp_eq_u32 vcc, -1, v60
    s_add_u32 s99, s99, 1
    s_cmp_gt_u32 s99, 0x8000
    s_cbranch_scc1 ok_30
    s_cbranch_vccnz re_29b
    s_branch ok_30
re_31:
    s_mov_b32 s99, 0
re_31b:
    buffer_load_dwordx4 v[44:47], v2, s[32:35], s67 offen offset:0 sc1
    buffer_load_dwordx4 v[48:51], v2, s[32:35], s67 offen offset:1024 sc1
    buffer_load_dwordx4 v[52:55], v2, s[32:35], s67 offen offset:2048 sc1
    buffer_load_dwordx4 v[56:59], v2, s[32:35], s67 offen offset:3072 sc1
    s_add_u32 s77, s67, 4096
    buffer_load_dwordx4 v[16:19], v2, s[32:35], s77 offen offset:0 sc1
    buffer_load_dwordx4 v[20:23], v2, s[32:35], s77 offen offset:1024 sc1
    buffer_load_dwordx4 v[36:39], v2, s[32:35], s77 offen offset:2048 sc1
    buffer_load_dwordx4 v[160:163], v2, s[32:35], s77 offen offset:3072 sc1
    s_waitcnt vmcnt(0)
    v_max_u32 v60, v44, v48
    v_max3_u32 v60, v60, v52, v56
    v_max3_u32 v60, v60, v16, v20
    v_max3_u32 v60, v60, v36, v160
    v_cmp_eq_u32 vcc, -1, v60
    s_add_u32 s99, s99, 1
    s_cmp_gt_u32 s99, 0x8000
    s_cbranch_scc1 ok_32
    s_cbranch_vccnz re_31b
    s_branch ok_32
L_last:
    s_endpgm
.section .rodata,"a"
.p2align 6
.amdhsa_kernel adaLN_cond__linear_kernel_hedgehog__glu_gated_glu__prompt_kernel
  .amdhsa_next_free_vgpr 512
  .amdhsa_next_free_sgpr 102
  .amdhsa_accum_offset 256
  .amdhsa_group_segment_fixed_size 0
  .amdhsa_kernarg_size 104
  .amdhsa_user_sgpr_count 2
  .amdhsa_user_sgpr_kernarg_segment_ptr 1
  .amdhsa_system_sgpr_workgroup_id_x 1
  .amdhsa_float_denorm_mode_32 3
.end_amdhsa_kernel
```
